```python
import torch

def _softmax(x, axis=-1):
    return torch.softmax(x, dim=axis)

def _gelu(x):
    return torch.nn.functional.gelu(x, approximate='tanh')

def _silu(x):
    return torch.nn.functional.silu(x)

def _sigmoid(x):
    return torch.sigmoid(x)

def _layernorm(x, axis=-1, eps=1e-05):
    m = x.mean(dim=axis, keepdim=True)
    v = x.var(dim=axis, keepdim=True, unbiased=False)
    return (x - m) / torch.sqrt(v + eps)

def _scatter_add(tgt, idx, src, axis=0):
    return tgt.clone().index_add_(axis, idx, src)

def _segment_sum(src, seg, n):
    out = torch.zeros((n,) + src.shape[1:], dtype=src.dtype)
    return out.index_add_(0, seg, src)

def _pad(x, pw):
    flat = tuple((v for pair in reversed(pw) for v in pair))
    return torch.nn.functional.pad(x, flat)
kernel_name = 'adaLN_cond__compressed_kv_cla__mixer_channel_mlp__decode'

def setup_inputs():

    _w = lambda a: (lambda t: t.to(torch.bfloat16) if t.is_floating_point() else t)(torch.as_tensor(a))

    def _A_setup():
        B, H, Sq, Sk, D, M = (2, 32, 1, 8192, 128, 512)
        Dc = 4 * D
        return {'x': _w((lambda *s: torch.randn(*s, dtype=torch.bfloat16) * 0.1)(B, Sq, M)), 'c_kv': _w((lambda *s: torch.randn(*s, dtype=torch.bfloat16) * 0.8)(B, Sk, Dc)), 'w_q': _w((lambda *s: torch.randn(*s, dtype=torch.bfloat16) * 0.8)(M, H, D) * M ** (-0.5)), 'w_uk': _w((lambda *s: torch.randn(*s, dtype=torch.bfloat16) * 0.8)(Dc, H, D) * Dc ** (-0.5)), 'w_uv': _w((lambda *s: torch.randn(*s, dtype=torch.bfloat16) * 0.8)(Dc, H, D) * Dc ** (-0.5)), 'w_o': _w((lambda *s: torch.randn(*s, dtype=torch.bfloat16) * 0.8)(H, D, M) * (H * D) ** (-0.5))}
    _A_in = _A_setup()

    def _B_setup():
        B, S, D, F = (2, 1, 512, 1792)
        return {'x': _w((lambda *s: torch.randn(*s, dtype=torch.bfloat16) * 0.1)(B, S, D)), 'w1': _w((lambda *s: torch.randn(*s, dtype=torch.bfloat16) * 3.2)(D, F) * D ** (-0.5)), 'b1': _w((lambda *s: torch.randn(*s, dtype=torch.bfloat16) * 3.2)(F)), 'w2': _w((lambda *s: torch.randn(*s, dtype=torch.bfloat16) * 0.8)(F, D) * F ** (-0.5)), 'b2': _w((lambda *s: torch.randn(*s, dtype=torch.bfloat16) * 1.6)(D))}
    _B_in = _B_setup()
    return {'A_x': _A_in['x'], 'A_c_kv': _A_in['c_kv'], 'A_w_q': _A_in['w_q'], 'A_w_uk': _A_in['w_uk'], 'A_w_uv': _A_in['w_uv'], 'A_w_o': _A_in['w_o'], 'B_x': _B_in['x'], 'B_w1': _B_in['w1'], 'B_b1': _B_in['b1'], 'B_w2': _B_in['w2'], 'B_b2': _B_in['b2'], 'c': _w((lambda *s: torch.randn(*s, dtype=torch.bfloat16) * 0.8)(2, 512) * 8.0), 'w_mod': _w((lambda *s: torch.randn(*s, dtype=torch.bfloat16) * 0.8)(512, 6 * 512) * 512 ** (-0.5) * 8.0)}

def reference(A_x, A_c_kv, A_w_q, A_w_uk, A_w_uv, A_w_o, B_x, B_w1, B_b1, B_w2, B_b2, c, w_mod):

    def _A_ref(x, c_kv, w_q, w_uk, w_uv, w_o):
        B, Sq, M = (x.shape[0], x.shape[1], x.shape[2])
        Sk = c_kv.shape[1]
        H, D = (w_q.shape[1], w_q.shape[2])
        q = torch.einsum('bqm,mhd->bhqd', x, w_q)
        k = torch.einsum('bkc,chd->bhkd', c_kv, w_uk)
        v = torch.einsum('bkc,chd->bhkd', c_kv, w_uv)
        scores = torch.einsum('bhqd,bhkd->bhqk', q, k) * D ** (-0.5)
        off = Sk - Sq
        qi = torch.arange(Sq)[:, None]
        kj = torch.arange(Sk)[None, :]
        cmask = kj <= qi + off
        scores = torch.where(cmask[None, None], scores, -1000000000.0)
        p = _softmax(scores, axis=-1)
        ctx = torch.einsum('bhqk,bhkd->bhqd', p, v)
        return torch.einsum('bhqd,hdm->bqm', ctx, w_o)

    def _B_ref(x, w1, b1, w2, b2):
        y = _layernorm(x, axis=-1)
        h = _gelu(torch.einsum('bsd,df->bsf', y, w1) + b1)
        return torch.einsum('bsf,fd->bsd', h, w2) + b2
    x = A_x
    mod = (_silu(c) @ w_mod).reshape(c.shape[0], 6, 1, -1)
    sa, ca, ga, sb, cb, gb = (mod[:, 0].clone(), mod[:, 1].clone(), mod[:, 2].clone(), mod[:, 3].clone(), mod[:, 4].clone(), mod[:, 5].clone())
    h = _layernorm(x, axis=-1) * (1 + ca) + sa
    x = x + ga * _A_ref(h, A_c_kv, A_w_q, A_w_uk, A_w_uv, A_w_o)
    h = _layernorm(x, axis=-1) * (1 + cb) + sb
    x = x + gb * _B_ref(h, B_w1, B_b1, B_w2, B_b2)
    return x
```

```asm
; @launch grid=(256,1,1) block=(512,1,1) lds=163840
.amdgcn_target "amdgcn-amd-amdhsa--gfx950"
.text
.globl adaLN_cond__compressed_kv_cla__mixer_channel_mlp__decode_kernel
.p2align 8
.type adaLN_cond__compressed_kv_cla__mixer_channel_mlp__decode_kernel,@function
adaLN_cond__compressed_kv_cla__mixer_channel_mlp__decode_kernel:
    s_cmp_ge_u32 s2, 256
    s_cbranch_scc1 END
    s_getpc_b64 s[76:77]
PC0:
    v_lshlrev_b32 v254, 7, v0
    v_mov_b32 v253, s77
    v_add_co_u32 v252, vcc, s76, v254
    s_nop 1
    v_addc_co_u32 v253, vcc, 0, v253, vcc
    s_mov_b32 s78, END-PC0
    s_cmp_ge_u32 s2, 160
    s_cselect_b32 s78, s78, 0
    v_cmp_gt_u32 vcc, s78, v254
    s_and_b64 exec, exec, vcc
    s_cbranch_execz NOPF
    global_load_dword v255, v[252:253], off
NOPF:
    s_mov_b64 exec, -1
    s_load_dwordx2 s[36:37], s[0:1], 96
    s_load_dwordx2 s[12:13], s[0:1], 16
    s_load_dwordx2 s[8:9], s[0:1], 8
    s_load_dwordx2 s[4:5], s[0:1], 120
    s_load_dwordx2 s[44:45], s[0:1], 88
    s_load_dwordx2 s[16:17], s[0:1], 24
    s_load_dwordx2 s[40:41], s[0:1], 0
    s_load_dwordx2 s[60:61], s[0:1], 112
    s_load_dwordx2 s[20:21], s[0:1], 32
    s_load_dwordx2 s[24:25], s[0:1], 40
    s_load_dwordx2 s[28:29], s[0:1], 56
    s_load_dwordx2 s[32:33], s[0:1], 72
    s_load_dwordx2 s[48:49], s[0:1], 64
    s_load_dwordx2 s[52:53], s[0:1], 80
    s_load_dwordx2 s[56:57], s[0:1], 104
    v_lshrrev_b32 v3, 6, v0
    v_and_b32 v1, 63, v0
    v_and_b32 v2, 15, v0
    v_readfirstlane_b32 s3, v3
    v_lshrrev_b32 v3, 4, v1
    s_and_b32 s64, s2, 7
    s_lshr_b32 s66, s2, 4
    s_mov_b32 s71, 0
    s_mov_b32 s6, 268435456
    s_mov_b32 s7, 0x00020000
    s_mov_b32 s62, 256
    s_mov_b32 s63, 0x00020000
    v_and_b32 v36, 2, v3
    v_add_u32 v36, v36, v3
    v_xor_b32 v36, v36, v2
    v_lshlrev_b32 v36, 4, v36
    v_mov_b32 v40, -1
    v_mov_b32 v41, -1
    v_mov_b32 v42, -1
    v_mov_b32 v43, -1
    v_mov_b32 v62, 0
    s_lshl_b32 s68, s3, 14
    s_add_u32 s73, s68, 32768
    s_lshr_b32 s67, s2, 3
    s_sub_u32 s66, s67, 4
    s_cmp_lt_u32 s66, 16
    s_cbranch_scc1 BPATH
    s_and_b32 s66, s67, 15
    s_mov_b32 s10, 16777216
    s_mov_b32 s11, 0x00020000
    s_lshl_b32 s67, s64, 4
    s_add_u32 s65, s67, s66
    s_lshl_b32 s72, s65, 17
    s_add_u32 s72, s72, s68
    v_lshl_add_u32 v12, v3, 10, v36
    v_xor_b32 v13, 4128, v12
    v_xor_b32 v14, 8320, v12
    v_xor_b32 v15, 12448, v12
    s_mov_b32 s76, s64
    s_mov_b32 s77, s66
    s_cmp_ge_u32 s66, 4
    s_cbranch_scc1 A_PLAIN
    s_mov_b32 s46, 2048
    s_mov_b32 s47, 0x00020000
    s_mov_b32 s38, 3145728
    s_mov_b32 s39, 0x00020000
    s_mov_b32 s42, 2048
    s_mov_b32 s43, 0x00020000
    v_lshrrev_b32 v46, 3, v2
    v_lshlrev_b32 v46, 10, v46
    v_lshl_or_b32 v46, v3, 3, v46
    v_and_b32 v47, 7, v2
    v_lshlrev_b32 v47, 4, v47
    v_lshrrev_b32 v48, 3, v2
    v_lshl_or_b32 v48, v48, 10, v47
    v_mul_u32_u24 v49, 24576, v3
    v_add_u32 v48, v48, v49
    v_and_b32 v49, 1, v3
    v_lshl_or_b32 v47, v49, 3, v47
    v_lshrrev_b32 v49, 1, v3
    v_lshl_or_b32 v50, v49, 12, v47
    v_lshl_or_b32 v51, v49, 10, v47
    v_lshlrev_b32 v52, 5, v1
    s_lshl_b32 s67, s77, 3
    s_add_u32 s67, s67, s3
    s_lshl_b32 s68, s67, 5
    s_mul_i32 s67, s67, 98304
    s_lshl_b32 s69, s76, 7
    s_add_u32 s67, s67, s69
    s_lshl_b32 s70, s77, 10
    s_add_u32 s70, s70, s69
    s_lshl_b32 s78, s77, 3
    s_add_u32 s78, s78, s76
    s_lshl_b32 s78, s78, 13
    s_add_u32 s78, s78, 65536
    v_lshlrev_b32 v44, 4, v0
    s_waitcnt lgkmcnt(0)
    buffer_load_dwordx2 v[36:37], v46, s[44:47], s68 offen
    buffer_store_dwordx4 v[40:43], v44, s[4:7], s78 offen sc1
    s_cmp_lg_u32 s3, 0
    s_cbranch_scc1 S1_W
    s_mov_b32 exec_lo, 0x00ff00ff
    s_mov_b32 exec_hi, 0x00ff00ff
    buffer_store_dwordx2 v[40:41], v50, s[4:7], s70 offen sc1
    s_mov_b64 exec, -1
    buffer_load_dwordx4 v[80:83], v52, s[40:43], 0 offen
    buffer_load_dwordx4 v[84:87], v52, s[40:43], 0 offen offset:16
    buffer_load_dwordx2 v[88:89], v51, s[40:43], s69 offen
S1_W:
    buffer_load_dwordx4 v[64:67], v48, s[36:39], s67 offen nt
    s_add_u32 s67, s67, 6144
    buffer_load_dwordx4 v[68:71], v48, s[36:39], s67 offen nt
    s_add_u32 s67, s67, 6144
    buffer_load_dwordx4 v[72:75], v48, s[36:39], s67 offen nt
    s_add_u32 s67, s67, 6144
    buffer_load_dwordx4 v[76:79], v48, s[36:39], s67 offen nt
    v_and_b32 v38, 1, v2
    v_lshlrev_b32 v38, 4, v38
    v_mov_b32 v39, 0xffff
    v_lshlrev_b32 v39, v38, v39
    v_bfe_u32 v38, v2, 1, 2
    v_cmp_eq_u32 vcc, 0, v38
    s_nop 1
    v_cndmask_b32 v32, 0, v39, vcc
    v_cmp_eq_u32 vcc, 1, v38
    s_nop 1
    v_cndmask_b32 v33, 0, v39, vcc
    v_cmp_eq_u32 vcc, 2, v38
    s_nop 1
    v_cndmask_b32 v34, 0, v39, vcc
    v_cmp_eq_u32 vcc, 3, v38
    s_nop 1
    v_cndmask_b32 v35, 0, v39, vcc
    v_mov_b32 v53, 1
    s_waitcnt vmcnt(5)
    v_lshlrev_b32 v96, 16, v36
    v_and_b32 v97, 0xffff0000, v36
    v_lshlrev_b32 v98, 16, v37
    v_and_b32 v99, 0xffff0000, v37
    v_mul_f32 v100, 0xbfb8aa3b, v96
    v_mul_f32 v101, 0xbfb8aa3b, v97
    v_mul_f32 v102, 0xbfb8aa3b, v98
    v_mul_f32 v103, 0xbfb8aa3b, v99
    v_exp_f32 v100, v100
    v_exp_f32 v101, v101
    v_exp_f32 v102, v102
    v_exp_f32 v103, v103
    v_add_f32 v100, 1.0, v100
    v_add_f32 v101, 1.0, v101
    v_add_f32 v102, 1.0, v102
    v_add_f32 v103, 1.0, v103
    v_rcp_f32 v100, v100
    v_rcp_f32 v101, v101
    v_rcp_f32 v102, v102
    v_rcp_f32 v103, v103
    v_mul_f32 v96, v96, v100
    v_mul_f32 v97, v97, v101
    v_mul_f32 v98, v98, v102
    v_mul_f32 v99, v99, v103
    v_cvt_pk_bf16_f32 v96, v96, v96
    v_cvt_pk_bf16_f32 v97, v97, v97
    v_cvt_pk_bf16_f32 v98, v98, v98
    v_cvt_pk_bf16_f32 v99, v99, v99
    v_and_b32 v128, v96, v32
    v_and_b32 v129, v96, v33
    v_and_b32 v130, v96, v34
    v_and_b32 v131, v96, v35
    v_and_b32 v132, v97, v32
    v_and_b32 v133, v97, v33
    v_and_b32 v134, v97, v34
    v_and_b32 v135, v97, v35
    v_and_b32 v136, v98, v32
    v_and_b32 v137, v98, v33
    v_and_b32 v138, v98, v34
    v_and_b32 v139, v98, v35
    v_and_b32 v140, v99, v32
    v_and_b32 v141, v99, v33
    v_and_b32 v142, v99, v34
    v_and_b32 v143, v99, v35
    s_cmp_lg_u32 s3, 1
    s_waitcnt vmcnt(4)
    s_barrier
    s_cbranch_scc1 S1_NA
    s_mov_b64 exec, 1
    buffer_atomic_add v53, v62, s[60:63], 0 offen sc0 sc1
    s_mov_b64 exec, -1
    s_waitcnt vmcnt(1)
S1_NA:
    s_add_u32 m0, s73, 0
    s_nop 0
    buffer_load_dwordx4 v12, s[8:11], s72 offen offset:0 lds
    s_add_u32 m0, s73, 1024
    s_nop 0
    buffer_load_dwordx4 v13, s[8:11], s72 offen offset:0 lds
    s_add_u32 m0, s73, 2048
    s_nop 0
    buffer_load_dwordx4 v14, s[8:11], s72 offen offset:0 lds
    s_add_u32 m0, s73, 3072
    s_nop 0
    buffer_load_dwordx4 v15, s[8:11], s72 offen offset:0 lds
    s_cmp_lg_u32 s3, 0
    s_cbranch_scc1 S1_NOLN
    v_lshlrev_b32 v96, 16, v80
    v_and_b32 v97, 0xffff0000, v80
    v_lshlrev_b32 v98, 16, v81
    v_and_b32 v99, 0xffff0000, v81
    v_lshlrev_b32 v100, 16, v82
    v_and_b32 v101, 0xffff0000, v82
    v_lshlrev_b32 v102, 16, v83
    v_and_b32 v103, 0xffff0000, v83
    v_lshlrev_b32 v104, 16, v84
    v_and_b32 v105, 0xffff0000, v84
    v_lshlrev_b32 v106, 16, v85
    v_and_b32 v107, 0xffff0000, v85
    v_lshlrev_b32 v108, 16, v86
    v_and_b32 v109, 0xffff0000, v86
    v_lshlrev_b32 v110, 16, v87
    v_and_b32 v111, 0xffff0000, v87
    v_pk_add_f32 v[112:113], v[96:97], v[98:99]
    v_pk_add_f32 v[112:113], v[112:113], v[100:101]
    v_pk_add_f32 v[112:113], v[112:113], v[102:103]
    v_pk_add_f32 v[112:113], v[112:113], v[104:105]
    v_pk_add_f32 v[112:113], v[112:113], v[106:107]
    v_pk_add_f32 v[112:113], v[112:113], v[108:109]
    v_pk_add_f32 v[112:113], v[112:113], v[110:111]
    v_add_f32 v112, v112, v113
    s_nop 1
    v_add_f32_dpp v112, v112, v112 row_ror:8 row_mask:0xf bank_mask:0xf
    s_nop 1
    v_add_f32_dpp v112, v112, v112 row_ror:4 row_mask:0xf bank_mask:0xf
    s_nop 1
    v_add_f32_dpp v112, v112, v112 row_ror:2 row_mask:0xf bank_mask:0xf
    s_nop 1
    v_add_f32_dpp v112, v112, v112 row_ror:1 row_mask:0xf bank_mask:0xf
    v_mov_b32 v113, v112
    s_nop 1
    v_permlane16_swap_b32 v112, v113
    v_add_f32 v112, v112, v113
    v_mul_f32 v112, 0x3b000000, v112
    v_sub_f32 v96, v96, v112
    v_sub_f32 v97, v97, v112
    v_sub_f32 v98, v98, v112
    v_sub_f32 v99, v99, v112
    v_sub_f32 v100, v100, v112
    v_sub_f32 v101, v101, v112
    v_sub_f32 v102, v102, v112
    v_sub_f32 v103, v103, v112
    v_sub_f32 v104, v104, v112
    v_sub_f32 v105, v105, v112
    v_sub_f32 v106, v106, v112
    v_sub_f32 v107, v107, v112
    v_sub_f32 v108, v108, v112
    v_sub_f32 v109, v109, v112
    v_sub_f32 v110, v110, v112
    v_sub_f32 v111, v111, v112
    v_mul_f32 v114, v96, v96
    v_fmac_f32 v114, v97, v97
    v_fmac_f32 v114, v98, v98
    v_fmac_f32 v114, v99, v99
    v_fmac_f32 v114, v100, v100
    v_fmac_f32 v114, v101, v101
    v_fmac_f32 v114, v102, v102
    v_fmac_f32 v114, v103, v103
    v_fmac_f32 v114, v104, v104
    v_fmac_f32 v114, v105, v105
    v_fmac_f32 v114, v106, v106
    v_fmac_f32 v114, v107, v107
    v_fmac_f32 v114, v108, v108
    v_fmac_f32 v114, v109, v109
    v_fmac_f32 v114, v110, v110
    v_fmac_f32 v114, v111, v111
    s_nop 1
    v_add_f32_dpp v114, v114, v114 row_ror:8 row_mask:0xf bank_mask:0xf
    s_nop 1
    v_add_f32_dpp v114, v114, v114 row_ror:4 row_mask:0xf bank_mask:0xf
    s_nop 1
    v_add_f32_dpp v114, v114, v114 row_ror:2 row_mask:0xf bank_mask:0xf
    s_nop 1
    v_add_f32_dpp v114, v114, v114 row_ror:1 row_mask:0xf bank_mask:0xf
    v_mov_b32 v113, v114
    s_nop 1
    v_permlane16_swap_b32 v114, v113
    v_add_f32 v114, v114, v113
    v_mov_b32 v113, 0x3727c5ac
    v_fmac_f32 v113, 0x3b000000, v114
    v_rsq_f32 v113, v113
    v_lshlrev_b32 v116, 16, v88
    v_and_b32 v117, 0xffff0000, v88
    v_lshlrev_b32 v118, 16, v89
    v_and_b32 v119, 0xffff0000, v89
    v_sub_f32 v116, v116, v112
    v_mul_f32 v116, v116, v113
    v_sub_f32 v117, v117, v112
    v_mul_f32 v117, v117, v113
    v_sub_f32 v118, v118, v112
    v_mul_f32 v118, v118, v113
    v_sub_f32 v119, v119, v112
    v_mul_f32 v119, v119, v113
    s_cmp_eq_u32 s77, 0
    s_cselect_b32 s67, 1.0, 0
    v_mov_b32 v120, s67
S1_NOLN:
    s_cmp_eq_u32 s3, 1
    s_cbranch_scc1 S1_W1
    s_waitcnt vmcnt(4)
S1_W1:
    v_mfma_f32_16x16x32_bf16 v[208:211], v[128:131], v[64:67], 0
    v_mfma_f32_16x16x32_bf16 v[208:211], v[132:135], v[68:71], v[208:211]
    v_mfma_f32_16x16x32_bf16 v[208:211], v[136:139], v[72:75], v[208:211]
    v_mfma_f32_16x16x32_bf16 v[208:211], v[140:143], v[76:79], v[208:211]
    s_lshl_b32 s67, s3, 10
    v_lshlrev_b32 v44, 4, v1
    v_add_u32 v45, s67, v44
    s_nop 4
    ds_write_b128 v45, v[208:211] offset:0
    s_waitcnt lgkmcnt(0)
    s_barrier
    s_cmp_lg_u32 s3, 1
    s_cbranch_scc1 S1_NF
    s_waitcnt vmcnt(4)
    v_readfirstlane_b32 s74, v53
    s_cmp_lg_u32 s74, 31
    s_cbranch_scc1 S1_DONE
    s_mov_b64 exec, 1
    buffer_store_dword v53, v62, s[60:63], 0 offen offset:128 sc1
    s_mov_b64 exec, -1
S1_NF:
    s_cmp_lg_u32 s3, 0
    s_cbranch_scc1 S1_DONE
    ds_read_b128 v[64:67], v44 offset:0
    ds_read_b128 v[68:71], v44 offset:1024
    ds_read_b128 v[72:75], v44 offset:2048
    ds_read_b128 v[76:79], v44 offset:3072
    ds_read_b128 v[80:83], v44 offset:4096
    ds_read_b128 v[84:87], v44 offset:5120
    ds_read_b128 v[88:91], v44 offset:6144
    ds_read_b128 v[92:95], v44 offset:7168
    s_waitcnt lgkmcnt(6)
    v_pk_add_f32 v[64:65], v[64:65], v[68:69]
    v_pk_add_f32 v[66:67], v[66:67], v[70:71]
    s_waitcnt lgkmcnt(4)
    v_pk_add_f32 v[72:73], v[72:73], v[76:77]
    v_pk_add_f32 v[74:75], v[74:75], v[78:79]
    v_pk_add_f32 v[64:65], v[64:65], v[72:73]
    v_pk_add_f32 v[66:67], v[66:67], v[74:75]
    s_waitcnt lgkmcnt(2)
    v_pk_add_f32 v[80:81], v[80:81], v[84:85]
    v_pk_add_f32 v[82:83], v[82:83], v[86:87]
    v_pk_add_f32 v[64:65], v[64:65], v[80:81]
    v_pk_add_f32 v[66:67], v[66:67], v[82:83]
    s_waitcnt lgkmcnt(0)
    v_pk_add_f32 v[88:89], v[88:89], v[92:93]
    v_pk_add_f32 v[90:91], v[90:91], v[94:95]
    v_pk_add_f32 v[64:65], v[64:65], v[88:89]
    v_pk_add_f32 v[66:67], v[66:67], v[90:91]
    s_nop 0
    v_add_f32_dpp v68, v64, v120 row_ror:8 row_mask:0xf bank_mask:0xf
    v_add_f32_dpp v69, v65, v120 row_ror:8 row_mask:0xf bank_mask:0xf
    v_add_f32_dpp v70, v66, v120 row_ror:8 row_mask:0xf bank_mask:0xf
    v_add_f32_dpp v71, v67, v120 row_ror:8 row_mask:0xf bank_mask:0xf
    v_fmac_f32 v64, v68, v116
    v_fmac_f32 v65, v69, v117
    v_fmac_f32 v66, v70, v118
    v_fmac_f32 v67, v71, v119
    v_cvt_pk_bf16_f32 v64, v64, v65
    v_cvt_pk_bf16_f32 v65, v66, v67
    s_mov_b32 exec_lo, 0x00ff00ff
    s_mov_b32 exec_hi, 0x00ff00ff
    buffer_store_dwordx2 v[64:65], v50, s[4:7], s70 offen sc1
    s_mov_b64 exec, -1
S1_DONE:
    s_barrier
    s_branch A2
A_PLAIN:
    s_waitcnt lgkmcnt(0)
    s_add_u32 m0, s73, 0
    s_nop 0
    buffer_load_dwordx4 v12, s[8:11], s72 offen offset:0 lds
    s_add_u32 m0, s73, 1024
    s_nop 0
    buffer_load_dwordx4 v13, s[8:11], s72 offen offset:0 lds
    s_add_u32 m0, s73, 2048
    s_nop 0
    buffer_load_dwordx4 v14, s[8:11], s72 offen offset:0 lds
    s_add_u32 m0, s73, 3072
    s_nop 0
    buffer_load_dwordx4 v15, s[8:11], s72 offen offset:0 lds
A2:
    s_add_u32 m0, s73, 3840
    s_nop 0
    buffer_load_dwordx4 v12, s[8:11], s72 offen offset:256 lds
    s_add_u32 m0, s73, 4864
    s_nop 0
    buffer_load_dwordx4 v13, s[8:11], s72 offen offset:256 lds
    s_add_u32 m0, s73, 5888
    s_nop 0
    buffer_load_dwordx4 v14, s[8:11], s72 offen offset:256 lds
    s_add_u32 m0, s73, 6912
    s_nop 0
    buffer_load_dwordx4 v15, s[8:11], s72 offen offset:256 lds
    s_add_u32 m0, s73, 7680
    s_nop 0
    buffer_load_dwordx4 v12, s[8:11], s72 offen offset:512 lds
    s_add_u32 m0, s73, 8704
    s_nop 0
    buffer_load_dwordx4 v13, s[8:11], s72 offen offset:512 lds
    s_add_u32 m0, s73, 9728
    s_nop 0
    buffer_load_dwordx4 v14, s[8:11], s72 offen offset:512 lds
    s_add_u32 m0, s73, 10752
    s_nop 0
    buffer_load_dwordx4 v15, s[8:11], s72 offen offset:512 lds
    s_cmp_eq_u32 s3, 7
    s_cselect_b64 exec, 1, 0
    buffer_load_dword v63, v62, s[60:63], 0 offen offset:128 sc1
    s_mov_b64 exec, -1
    s_add_u32 m0, s73, 11520
    s_nop 0
    buffer_load_dwordx4 v12, s[8:11], s72 offen offset:768 lds
    s_add_u32 m0, s73, 12544
    s_nop 0
    buffer_load_dwordx4 v13, s[8:11], s72 offen offset:768 lds
    s_add_u32 m0, s73, 13568
    s_nop 0
    buffer_load_dwordx4 v14, s[8:11], s72 offen offset:768 lds
    s_add_u32 m0, s73, 14592
    s_nop 0
    buffer_load_dwordx4 v15, s[8:11], s72 offen offset:768 lds
    v_and_b32 v37, 9, v2
    v_and_b32 v38, 2, v2
    v_lshl_or_b32 v37, v38, 1, v37
    v_bfe_u32 v38, v2, 2, 1
    v_lshl_or_b32 v37, v38, 1, v37
    v_xor_b32 v38, v37, v3
    v_lshlrev_b32 v38, 4, v38
    v_lshl_or_b32 v4, v2, 8, v38
    v_xor_b32 v5, 64, v4
    v_xor_b32 v6, 128, v4
    v_xor_b32 v7, 192, v4
    v_add_u32 v8, s73, v4
    v_add_u32 v9, s73, v5
    v_add_u32 v10, s73, v6
    v_add_u32 v11, s73, v7
    s_lshl_b32 s67, s3, 1
    v_lshrrev_b32 v38, 1, v3
    v_or_b32 v38, s67, v38
    v_xor_b32 v38, v38, v37
    v_lshlrev_b32 v38, 4, v38
    v_lshl_or_b32 v38, v2, 8, v38
    v_and_b32 v39, 1, v3
    v_lshl_or_b32 v61, v39, 3, v38
    v_and_b32 v38, 1, v2
    v_lshlrev_b32 v38, 4, v38
    v_mov_b32 v39, 0xffff
    v_lshlrev_b32 v39, v38, v39
    v_bfe_u32 v38, v2, 1, 2
    v_cmp_eq_u32 vcc, 0, v38
    s_nop 1
    v_cndmask_b32 v32, 0, v39, vcc
    v_cmp_eq_u32 vcc, 1, v38
    s_nop 1
    v_cndmask_b32 v33, 0, v39, vcc
    v_cmp_eq_u32 vcc, 2, v38
    s_nop 1
    v_cndmask_b32 v34, 0, v39, vcc
    v_cmp_eq_u32 vcc, 3, v38
    s_nop 1
    v_cndmask_b32 v35, 0, v39, vcc
    s_mov_b32 s30, 1835008
    s_mov_b32 s31, 0x00020000
    s_mov_b32 s34, 1835008
    s_mov_b32 s35, 0x00020000
    s_mov_b32 s50, 3584
    s_mov_b32 s51, 0x00020000
    s_mov_b32 s54, 1024
    s_mov_b32 s55, 0x00020000
    s_mov_b32 s42, 2048
    s_mov_b32 s43, 0x00020000
    s_mov_b32 s58, 2048
    s_mov_b32 s59, 0x00020000
    v_lshrrev_b32 v47, 2, v2
    v_and_b32 v48, 3, v2
    v_and_b32 v49, 1, v3
    v_and_b32 v50, 2, v47
    v_add_u32 v50, v50, v47
    v_xor_b32 v50, v50, v48
    s_and_b32 s68, s3, 1
    v_xor_b32 v51, s68, v49
    v_lshl_or_b32 v50, v51, 3, v50
    v_lshlrev_b32 v50, 4, v50
    v_and_b32 v51, 1, v48
    v_lshl_or_b32 v50, v51, 3, v50
    v_lshl_or_b32 v51, v49, 3, v47
    v_lshl_or_b32 v50, v51, 8, v50
    v_lshrrev_b32 v51, 1, v3
    v_lshl_or_b32 v50, v51, 14, v50
    s_lshr_b32 s68, s3, 1
    s_lshl_b32 s68, s68, 12
    s_add_u32 s68, s68, 32768
    v_add_u32 v16, s68, v50
    v_xor_b32 v17, 1056, v16
    v_xor_b32 v18, 8, v16
    v_xor_b32 v19, 1064, v16
    v_xor_b32 v20, 64, v16
    v_xor_b32 v21, 1120, v16
    v_xor_b32 v22, 72, v16
    v_xor_b32 v23, 1128, v16
    v_add_u32 v24, 0x10000, v16
    v_add_u32 v25, 0x10000, v17
    v_add_u32 v26, 0x10000, v18
    v_add_u32 v27, 0x10000, v19
    v_add_u32 v28, 0x10000, v20
    v_add_u32 v29, 0x10000, v21
    v_add_u32 v30, 0x10000, v22
    v_add_u32 v31, 0x10000, v23
    v_lshrrev_b32 v46, 3, v1
    v_and_b32 v47, 2, v46
    v_and_b32 v54, 7, v1
    v_xor_b32 v54, v54, v47
    v_lshlrev_b32 v54, 4, v54
    v_lshl_or_b32 v54, v46, 10, v54
    v_xor_b32 v55, 64, v54
    v_lshrrev_b32 v46, 2, v1
    v_and_b32 v47, 2, v3
    v_and_b32 v56, 3, v1
    v_xor_b32 v56, v56, v47
    v_lshlrev_b32 v56, 4, v56
    v_mul_u32_u24 v46, 3584, v46
    v_add_u32 v56, v56, v46
    s_and_b32 s68, s3, 1
    s_lshl_b32 s68, s68, 1
    s_and_b32 s69, s3, 2
    s_lshl_b32 s69, s69, 2
    s_or_b32 s68, s68, s69
    v_xor_b32 v45, s68, v2
    v_lshlrev_b32 v45, 4, v45
    v_lshl_or_b32 v45, v3, 12, v45
    s_and_b32 s68, s3, 3
    s_lshl_b32 s68, s68, 10
    s_and_b32 s69, s3, 4
    s_lshl_b32 s69, s69, 12
    s_or_b32 s68, s68, s69
    v_or_b32 v45, s68, v45
    v_xor_b32 v46, 0x110, v45
    v_xor_b32 v47, 0x240, v45
    v_xor_b32 v48, 0x350, v45
    v_lshlrev_b32 v44, 4, v1
    s_lshr_b32 s67, s64, 2
    s_lshl_b32 s67, s67, 3
    s_add_u32 s67, s67, s3
    s_lshl_b32 s67, s67, 12
    s_add_u32 s67, s67, 65536
    s_waitcnt vmcnt(8)
    ds_read_b128 v[64:67], v8 offset:0
    ds_read_b128 v[68:71], v9 offset:0
    ds_read_b128 v[72:75], v10 offset:0
    ds_read_b128 v[76:79], v11 offset:0
    ds_read_b128 v[80:83], v8 offset:4096
    ds_read_b128 v[84:87], v9 offset:4096
    ds_read_b128 v[88:91], v10 offset:4096
    ds_read_b128 v[92:95], v11 offset:4096
    v_and_b32 v49, 1, v3
    v_lshlrev_b32 v49, 9, v49
    v_lshl_or_b32 v49, v2, 5, v49
    s_lshl_b32 s69, s3, 2
    v_add_u32 v59, s69, v49
    v_and_b32 v50, 7, v2
    v_lshlrev_b32 v50, 10, v50
    v_lshl_or_b32 v50, v3, 4, v50
    v_lshrrev_b32 v51, 3, v2
    v_lshl_or_b32 v50, v51, 6, v50
    v_lshlrev_b32 v51, 3, v2
    v_mov_b32 v248, 0x3f803f80
    v_mov_b32 v249, 0x3f803f80
    v_mov_b32 v250, 0x3f803f80
    v_mov_b32 v251, 0x3f803f80
    s_and_b32 s68, s3, 1
    s_lshl_b32 s68, s68, 7
    s_add_u32 s69, s68, s65
    s_lshl_b32 s70, s69, 7
    s_add_u32 s70, s70, 262144
    s_lshl_b32 s69, s69, 14
    s_lshl_b32 s77, s3, 7
    s_add_u32 s69, s69, s77
    s_xor_b32 s77, s69, 2097152
    s_add_u32 s69, s69, 1048576
    s_add_u32 s77, s77, 1048576
    s_lshl_b32 s76, s64, 3
    s_cmp_ge_u32 s66, 8
    s_cselect_b32 s76, s76, 64
    s_and_b32 s66, s66, 7
    s_add_u32 s76, s76, s66
    s_lshl_b32 s73, s3, 12
    s_add_u32 s73, s73, 65536
    s_waitcnt vmcnt(4)
    ds_read_b128 v[96:99], v8 offset:8192
    ds_read_b128 v[100:103], v9 offset:8192
    ds_read_b128 v[104:107], v10 offset:8192
    ds_read_b128 v[108:111], v11 offset:8192
    s_cmp_lg_u32 s3, 7
    s_cbranch_scc1 AC_OK
AC_CK:
    v_readfirstlane_b32 s74, v63
    s_cmp_lg_u32 s74, 0
    s_cbranch_scc1 AC_OK
    s_cmp_eq_u32 s3, 7
    s_cselect_b64 exec, 1, 0
    buffer_load_dword v63, v62, s[60:63], 0 offen offset:128 sc1
    s_mov_b64 exec, -1
    s_add_u32 s71, s71, 1
    s_cmp_lt_u32 s71, 65536
    s_waitcnt vmcnt(0)
    s_cbranch_scc1 AC_CK
AC_OK:
    s_barrier
    buffer_load_dwordx4 v[192:195], v44, s[4:7], s67 offen offset:0 sc1
    buffer_load_dwordx4 v[196:199], v44, s[4:7], s67 offen offset:1024 sc1
    buffer_load_dwordx4 v[200:203], v44, s[4:7], s67 offen offset:2048 sc1
    buffer_load_dwordx4 v[204:207], v44, s[4:7], s67 offen offset:3072 sc1
    s_waitcnt vmcnt(4)
    ds_read_b128 v[112:115], v8 offset:12288
    ds_read_b128 v[116:119], v9 offset:12288
    ds_read_b128 v[120:123], v10 offset:12288
    ds_read_b128 v[124:127], v11 offset:12288
    s_barrier
    buffer_store_dwordx4 v[40:43], v50, s[4:7], s69 offen sc1
    s_add_u32 s74, s69, 8192
    buffer_store_dwordx4 v[40:43], v50, s[4:7], s74 offen sc1
    buffer_store_dwordx4 v[40:43], v50, s[4:7], s77 offen sc1
    s_add_u32 s74, s77, 8192
    buffer_store_dwordx4 v[40:43], v50, s[4:7], s74 offen sc1
    s_lshl_b32 s74, s65, 10
    s_add_u32 s74, s74, 327680
    s_lshl_b32 s75, s3, 7
    s_add_u32 s74, s74, s75
    s_mov_b64 exec, 0xff
    buffer_store_dwordx4 v[40:43], v44, s[4:7], s74 offen sc1
    s_mov_b64 exec, -1
    ds_read_b64_tr_b16 v[128:129], v16 offset:0
    ds_read_b64_tr_b16 v[130:131], v17 offset:0
    ds_read_b64_tr_b16 v[132:133], v18 offset:0
    ds_read_b64_tr_b16 v[134:135], v19 offset:0
    ds_read_b64_tr_b16 v[136:137], v20 offset:0
    ds_read_b64_tr_b16 v[138:139], v21 offset:0
    ds_read_b64_tr_b16 v[140:141], v22 offset:0
    ds_read_b64_tr_b16 v[142:143], v23 offset:0
    ds_read_b64_tr_b16 v[144:145], v16 offset:32768
    ds_read_b64_tr_b16 v[146:147], v17 offset:32768
    ds_read_b64_tr_b16 v[148:149], v18 offset:32768
    ds_read_b64_tr_b16 v[150:151], v19 offset:32768
    ds_read_b64_tr_b16 v[152:153], v20 offset:32768
    ds_read_b64_tr_b16 v[154:155], v21 offset:32768
    ds_read_b64_tr_b16 v[156:157], v22 offset:32768
    ds_read_b64_tr_b16 v[158:159], v23 offset:32768
    ds_read_b64_tr_b16 v[160:161], v24 offset:0
    ds_read_b64_tr_b16 v[162:163], v25 offset:0
    ds_read_b64_tr_b16 v[164:165], v26 offset:0
    ds_read_b64_tr_b16 v[166:167], v27 offset:0
    ds_read_b64_tr_b16 v[168:169], v28 offset:0
    ds_read_b64_tr_b16 v[170:171], v29 offset:0
    ds_read_b64_tr_b16 v[172:173], v30 offset:0
    ds_read_b64_tr_b16 v[174:175], v31 offset:0
    ds_read_b64_tr_b16 v[176:177], v24 offset:32768
    ds_read_b64_tr_b16 v[178:179], v25 offset:32768
    ds_read_b64_tr_b16 v[180:181], v26 offset:32768
    ds_read_b64_tr_b16 v[182:183], v27 offset:32768
    ds_read_b64_tr_b16 v[184:185], v28 offset:32768
    ds_read_b64_tr_b16 v[186:187], v29 offset:32768
    ds_read_b64_tr_b16 v[188:189], v30 offset:32768
    ds_read_b64_tr_b16 v[190:191], v31 offset:32768
    s_lshl_b32 s68, s68, 5
    v_or_b32 v8, s68, v4
    v_xor_b32 v12, 0x1000, v8
    v_or_b32 v9, s68, v5
    v_xor_b32 v13, 0x1000, v9
    v_or_b32 v10, s68, v6
    v_xor_b32 v14, 0x1000, v10
    v_or_b32 v11, s68, v7
    v_xor_b32 v15, 0x1000, v11
    s_waitcnt vmcnt(5)
    s_branch H3W
H3L:
    buffer_load_dwordx4 v[192:195], v44, s[4:7], s67 offen offset:0 sc1
    buffer_load_dwordx4 v[196:199], v44, s[4:7], s67 offen offset:1024 sc1
    buffer_load_dwordx4 v[200:203], v44, s[4:7], s67 offen offset:2048 sc1
    buffer_load_dwordx4 v[204:207], v44, s[4:7], s67 offen offset:3072 sc1
    s_waitcnt vmcnt(0)
H3W:
    v_max3_u32 v52, v195, v199, v203
    v_max_u32 v52, v52, v207
    v_cmp_eq_u32 vcc, -1, v52
    s_nop 0
    s_cbranch_vccz H3OK
    s_mov_b32 exec_lo, 0x0
    s_mov_b32 exec_hi, 0x80000000
H3G:
    v_cmp_eq_u32 vcc, -1, v207
    s_nop 0
    s_cbranch_vccz H3R
    buffer_load_dwordx4 v[204:207], v44, s[4:7], s67 offen offset:3072 sc1
    s_add_u32 s71, s71, 1
    s_cmp_lt_u32 s71, 65536
    s_waitcnt vmcnt(0)
    s_cbranch_scc1 H3G
H3R:
    s_mov_b64 exec, -1
    v_cmp_eq_u32 vcc, -1, v195
    s_mov_b64 exec, vcc
    buffer_load_dwordx4 v[192:195], v44, s[4:7], s67 offen offset:0 sc1
    s_mov_b64 exec, -1
    v_cmp_eq_u32 vcc, -1, v199
    s_mov_b64 exec, vcc
    buffer_load_dwordx4 v[196:199], v44, s[4:7], s67 offen offset:1024 sc1
    s_mov_b64 exec, -1
    v_cmp_eq_u32 vcc, -1, v203
    s_mov_b64 exec, vcc
    buffer_load_dwordx4 v[200:203], v44, s[4:7], s67 offen offset:2048 sc1
    s_mov_b64 exec, -1
    v_cmp_eq_u32 vcc, -1, v207
    s_mov_b64 exec, vcc
    buffer_load_dwordx4 v[204:207], v44, s[4:7], s67 offen offset:3072 sc1
    s_mov_b64 exec, -1
    s_waitcnt vmcnt(0)
    s_add_u32 s71, s71, 1
    s_cmp_lt_u32 s71, 65536
    s_cbranch_scc1 H3W
H3OK:
    ds_write_b128 v45, v[192:195] offset:0
    ds_write_b128 v46, v[196:199] offset:0
    ds_write_b128 v47, v[200:203] offset:0
    ds_write_b128 v48, v[204:207] offset:0
    s_waitcnt lgkmcnt(0)
    s_barrier
    ds_read_b128 v[192:195], v4 offset:0
    ds_read_b128 v[196:199], v4 offset:16384
    ds_read_b128 v[200:203], v5 offset:0
    ds_read_b128 v[204:207], v5 offset:16384
    ds_read_b128 v[208:211], v6 offset:0
    ds_read_b128 v[212:215], v6 offset:16384
    ds_read_b128 v[216:219], v7 offset:0
    ds_read_b128 v[220:223], v7 offset:16384
    ds_read_b128 v[224:227], v4 offset:4096
    ds_read_b128 v[228:231], v4 offset:20480
    ds_read_b128 v[232:235], v5 offset:4096
    ds_read_b128 v[236:239], v5 offset:20480
    s_waitcnt lgkmcnt(11)
    v_mfma_f32_16x16x32_bf16 v[240:243], v[64:67], v[192:195], 0
    s_waitcnt lgkmcnt(10)
    v_mfma_f32_16x16x32_bf16 v[244:247], v[64:67], v[196:199], 0
    ds_read_b128 v[192:195], v6 offset:4096
    s_waitcnt lgkmcnt(10)
    v_mfma_f32_16x16x32_bf16 v[240:243], v[68:71], v[200:203], v[240:243]
    ds_read_b128 v[196:199], v6 offset:20480
    s_waitcnt lgkmcnt(10)
    v_mfma_f32_16x16x32_bf16 v[244:247], v[68:71], v[204:207], v[244:247]
    ds_read_b128 v[200:203], v7 offset:4096
    s_waitcnt lgkmcnt(10)
    v_mfma_f32_16x16x32_bf16 v[240:243], v[72:75], v[208:211], v[240:243]
    ds_read_b128 v[204:207], v7 offset:20480
    s_waitcnt lgkmcnt(10)
    v_mfma_f32_16x16x32_bf16 v[244:247], v[72:75], v[212:215], v[244:247]
    ds_read_b128 v[208:211], v4 offset:8192
    s_waitcnt lgkmcnt(10)
    v_mfma_f32_16x16x32_bf16 v[240:243], v[76:79], v[216:219], v[240:243]
    ds_read_b128 v[212:215], v4 offset:24576
    s_waitcnt lgkmcnt(10)
    v_mfma_f32_16x16x32_bf16 v[244:247], v[76:79], v[220:223], v[244:247]
    ds_read_b128 v[216:219], v5 offset:8192
    s_waitcnt lgkmcnt(10)
    v_mfma_f32_16x16x32_bf16 v[240:243], v[80:83], v[224:227], v[240:243]
    ds_read_b128 v[220:223], v5 offset:24576
    s_waitcnt lgkmcnt(10)
    v_mfma_f32_16x16x32_bf16 v[244:247], v[80:83], v[228:231], v[244:247]
    ds_read_b128 v[224:227], v6 offset:8192
    s_waitcnt lgkmcnt(10)
    v_mfma_f32_16x16x32_bf16 v[240:243], v[84:87], v[232:235], v[240:243]
    ds_read_b128 v[228:231], v6 offset:24576
    s_waitcnt lgkmcnt(10)
    v_mfma_f32_16x16x32_bf16 v[244:247], v[84:87], v[236:239], v[244:247]
    ds_read_b128 v[232:235], v7 offset:8192
    s_waitcnt lgkmcnt(10)
    v_mfma_f32_16x16x32_bf16 v[240:243], v[88:91], v[192:195], v[240:243]
    ds_read_b128 v[236:239], v7 offset:24576
    s_waitcnt lgkmcnt(10)
    v_mfma_f32_16x16x32_bf16 v[244:247], v[88:91], v[196:199], v[244:247]
    ds_read_b128 v[192:195], v4 offset:12288
    s_waitcnt lgkmcnt(10)
    v_mfma_f32_16x16x32_bf16 v[240:243], v[92:95], v[200:203], v[240:243]
    ds_read_b128 v[196:199], v4 offset:28672
    s_waitcnt lgkmcnt(10)
    v_mfma_f32_16x16x32_bf16 v[244:247], v[92:95], v[204:207], v[244:247]
    ds_read_b128 v[200:203], v5 offset:12288
    s_waitcnt lgkmcnt(10)
    v_mfma_f32_16x16x32_bf16 v[240:243], v[96:99], v[208:211], v[240:243]
    ds_read_b128 v[204:207], v5 offset:28672
    s_waitcnt lgkmcnt(10)
    v_mfma_f32_16x16x32_bf16 v[244:247], v[96:99], v[212:215], v[244:247]
    ds_read_b128 v[208:211], v6 offset:12288
    s_waitcnt lgkmcnt(10)
    v_mfma_f32_16x16x32_bf16 v[240:243], v[100:103], v[216:219], v[240:243]
    ds_read_b128 v[212:215], v6 offset:28672
    s_waitcnt lgkmcnt(10)
    v_mfma_f32_16x16x32_bf16 v[244:247], v[100:103], v[220:223], v[244:247]
    ds_read_b128 v[216:219], v7 offset:12288
    s_waitcnt lgkmcnt(10)
    v_mfma_f32_16x16x32_bf16 v[240:243], v[104:107], v[224:227], v[240:243]
    ds_read_b128 v[220:223], v7 offset:28672
    s_waitcnt lgkmcnt(10)
    v_mfma_f32_16x16x32_bf16 v[244:247], v[104:107], v[228:231], v[244:247]
    s_waitcnt lgkmcnt(9)
    v_mfma_f32_16x16x32_bf16 v[240:243], v[108:111], v[232:235], v[240:243]
    s_waitcnt lgkmcnt(8)
    v_mfma_f32_16x16x32_bf16 v[244:247], v[108:111], v[236:239], v[244:247]
    s_waitcnt lgkmcnt(7)
    v_mfma_f32_16x16x32_bf16 v[240:243], v[112:115], v[192:195], v[240:243]
    s_waitcnt lgkmcnt(6)
    v_mfma_f32_16x16x32_bf16 v[244:247], v[112:115], v[196:199], v[244:247]
    s_waitcnt lgkmcnt(5)
    v_mfma_f32_16x16x32_bf16 v[240:243], v[116:119], v[200:203], v[240:243]
    s_waitcnt lgkmcnt(4)
    v_mfma_f32_16x16x32_bf16 v[244:247], v[116:119], v[204:207], v[244:247]
    s_waitcnt lgkmcnt(3)
    v_mfma_f32_16x16x32_bf16 v[240:243], v[120:123], v[208:211], v[240:243]
    s_waitcnt lgkmcnt(2)
    v_mfma_f32_16x16x32_bf16 v[244:247], v[120:123], v[212:215], v[244:247]
    s_waitcnt lgkmcnt(1)
    v_mfma_f32_16x16x32_bf16 v[240:243], v[124:127], v[216:219], v[240:243]
    s_waitcnt lgkmcnt(0)
    v_mfma_f32_16x16x32_bf16 v[244:247], v[124:127], v[220:223], v[244:247]
    s_nop 5
    v_max3_f32 v52, v240, v241, v242
    v_max_f32 v52, v52, v243
    v_max3_f32 v53, v244, v245, v246
    v_max_f32 v53, v53, v247
    s_nop 1
    v_permlane16_swap_b32 v52, v53
    v_max_f32 v52, v52, v53
    v_mov_b32 v53, v52
    s_nop 1
    v_permlane32_swap_b32 v52, v53
    v_max_f32 v52, v52, v53
    s_mov_b32 exec_hi, 0
    ds_write_b32 v59, v52 offset:40960
    s_mov_b64 exec, -1
    s_waitcnt lgkmcnt(0)
    s_barrier
    ds_read_b128 v[36:39], v49 offset:40960
    ds_read_b128 v[40:43], v49 offset:40976
    s_bitcmp1_b32 s3, 0
    s_cselect_b64 vcc, -1, 0
    s_waitcnt lgkmcnt(1)
    v_max3_f32 v52, v36, v37, v38
    s_waitcnt lgkmcnt(0)
    v_max3_f32 v53, v39, v40, v41
    v_max3_f32 v52, v52, v42, v43
    v_max_f32 v52, v52, v53
    v_mov_b32 v53, v52
    s_nop 1
    v_permlane16_swap_b32 v52, v53
    v_sub_f32 v240, v240, v52
    v_sub_f32 v241, v241, v52
    v_sub_f32 v242, v242, v52
    v_sub_f32 v243, v243, v52
    v_sub_f32 v244, v244, v53
    v_sub_f32 v245, v245, v53
    v_sub_f32 v246, v246, v53
    v_sub_f32 v247, v247, v53
    v_exp_f32 v240, v240
    v_exp_f32 v241, v241
    v_exp_f32 v242, v242
    v_exp_f32 v243, v243
    v_exp_f32 v244, v244
    v_exp_f32 v245, v245
    v_exp_f32 v246, v246
    v_exp_f32 v247, v247
    v_cvt_pk_bf16_f32 v240, v240, v241
    v_cvt_pk_bf16_f32 v241, v242, v243
    ds_write_b64 v61, v[240:241] offset:32768
    v_cvt_pk_bf16_f32 v244, v244, v245
    v_cvt_pk_bf16_f32 v245, v246, v247
    ds_write_b64 v61, v[244:245] offset:36864
    v_cndmask_b32 v52, v52, v53, vcc
    s_waitcnt vmcnt(0) lgkmcnt(0)
    s_barrier
    ds_read_b128 v[192:195], v8 offset:32768
    ds_read_b128 v[196:199], v9 offset:32768
    ds_read_b128 v[200:203], v10 offset:32768
    ds_read_b128 v[204:207], v11 offset:32768
    ds_read_b128 v[208:211], v12 offset:32768
    ds_read_b128 v[212:215], v13 offset:32768
    ds_read_b128 v[216:219], v14 offset:32768
    ds_read_b128 v[220:223], v15 offset:32768
    s_cmp_ge_u32 s3, 2
    s_cbranch_scc1 NOL
    s_waitcnt lgkmcnt(7)
    v_mfma_f32_16x16x32_bf16 v[96:99], v[248:251], v[192:195], 0
    s_waitcnt lgkmcnt(6)
    v_mfma_f32_16x16x32_bf16 v[96:99], v[248:251], v[196:199], v[96:99]
    s_waitcnt lgkmcnt(5)
    v_mfma_f32_16x16x32_bf16 v[96:99], v[248:251], v[200:203], v[96:99]
    s_waitcnt lgkmcnt(4)
    v_mfma_f32_16x16x32_bf16 v[96:99], v[248:251], v[204:207], v[96:99]
NOL:
    s_waitcnt lgkmcnt(7)
    v_mfma_f32_16x16x32_bf16 v[64:67], v[128:131], v[192:195], 0
    v_mfma_f32_16x16x32_bf16 v[68:71], v[132:135], v[192:195], 0
    v_mfma_f32_16x16x32_bf16 v[72:75], v[136:139], v[192:195], 0
    v_mfma_f32_16x16x32_bf16 v[76:79], v[140:143], v[192:195], 0
    s_nop 2
    v_mov_b32 v53, v96
    s_cmp_lt_u32 s3, 2
    s_cselect_b64 exec, 0xffff, 0
    buffer_store_dwordx2 v[52:53], v51, s[4:7], s70 offen sc1
    s_mov_b64 exec, -1
    s_waitcnt lgkmcnt(6)
    v_mfma_f32_16x16x32_bf16 v[64:67], v[144:147], v[196:199], v[64:67]
    v_mfma_f32_16x16x32_bf16 v[68:71], v[148:151], v[196:199], v[68:71]
    v_mfma_f32_16x16x32_bf16 v[72:75], v[152:155], v[196:199], v[72:75]
    v_mfma_f32_16x16x32_bf16 v[76:79], v[156:159], v[196:199], v[76:79]
    s_waitcnt lgkmcnt(5)
    v_mfma_f32_16x16x32_bf16 v[64:67], v[160:163], v[200:203], v[64:67]
    v_mfma_f32_16x16x32_bf16 v[68:71], v[164:167], v[200:203], v[68:71]
    v_mfma_f32_16x16x32_bf16 v[72:75], v[168:171], v[200:203], v[72:75]
    v_mfma_f32_16x16x32_bf16 v[76:79], v[172:175], v[200:203], v[76:79]
    s_waitcnt lgkmcnt(4)
    v_mfma_f32_16x16x32_bf16 v[64:67], v[176:179], v[204:207], v[64:67]
    v_mfma_f32_16x16x32_bf16 v[68:71], v[180:183], v[204:207], v[68:71]
    v_mfma_f32_16x16x32_bf16 v[72:75], v[184:187], v[204:207], v[72:75]
    v_mfma_f32_16x16x32_bf16 v[76:79], v[188:191], v[204:207], v[76:79]
    s_waitcnt lgkmcnt(3)
    v_mfma_f32_16x16x32_bf16 v[80:83], v[128:131], v[208:211], 0
    v_mfma_f32_16x16x32_bf16 v[84:87], v[132:135], v[208:211], 0
    v_mfma_f32_16x16x32_bf16 v[88:91], v[136:139], v[208:211], 0
    v_mfma_f32_16x16x32_bf16 v[92:95], v[140:143], v[208:211], 0
    v_cvt_pk_bf16_f32 v100, v64, v65
    v_cvt_pk_bf16_f32 v101, v66, v67
    v_cvt_pk_bf16_f32 v102, v68, v69
    v_cvt_pk_bf16_f32 v103, v70, v71
    v_cvt_pk_bf16_f32 v104, v72, v73
    v_cvt_pk_bf16_f32 v105, v74, v75
    v_cvt_pk_bf16_f32 v106, v76, v77
    v_cvt_pk_bf16_f32 v107, v78, v79
    v_mov_b32 v116, v100
    v_mov_b32 v117, v101
    v_mov_b32 v118, v102
    v_mov_b32 v119, v103
    v_mov_b32_dpp v100, v104 row_ror:8 row_mask:0xf bank_mask:0xc
    v_mov_b32_dpp v101, v105 row_ror:8 row_mask:0xf bank_mask:0xc
    v_mov_b32_dpp v102, v106 row_ror:8 row_mask:0xf bank_mask:0xc
    v_mov_b32_dpp v103, v107 row_ror:8 row_mask:0xf bank_mask:0xc
    buffer_store_dwordx4 v[100:103], v50, s[4:7], s69 offen sc1
    v_mov_b32_dpp v104, v116 row_ror:8 row_mask:0xf bank_mask:0x3
    v_mov_b32_dpp v105, v117 row_ror:8 row_mask:0xf bank_mask:0x3
    v_mov_b32_dpp v106, v118 row_ror:8 row_mask:0xf bank_mask:0x3
    v_mov_b32_dpp v107, v119 row_ror:8 row_mask:0xf bank_mask:0x3
    s_add_u32 s69, s69, 8192
    buffer_store_dwordx4 v[104:107], v50, s[4:7], s69 offen sc1
    s_waitcnt lgkmcnt(2)
    v_mfma_f32_16x16x32_bf16 v[80:83], v[144:147], v[212:215], v[80:83]
    v_mfma_f32_16x16x32_bf16 v[84:87], v[148:151], v[212:215], v[84:87]
    v_mfma_f32_16x16x32_bf16 v[88:91], v[152:155], v[212:215], v[88:91]
    v_mfma_f32_16x16x32_bf16 v[92:95], v[156:159], v[212:215], v[92:95]
    s_waitcnt lgkmcnt(1)
    v_mfma_f32_16x16x32_bf16 v[80:83], v[160:163], v[216:219], v[80:83]
    v_mfma_f32_16x16x32_bf16 v[84:87], v[164:167], v[216:219], v[84:87]
    v_mfma_f32_16x16x32_bf16 v[88:91], v[168:171], v[216:219], v[88:91]
    v_mfma_f32_16x16x32_bf16 v[92:95], v[172:175], v[216:219], v[92:95]
    s_waitcnt lgkmcnt(0)
    v_mfma_f32_16x16x32_bf16 v[80:83], v[176:179], v[220:223], v[80:83]
    v_mfma_f32_16x16x32_bf16 v[84:87], v[180:183], v[220:223], v[84:87]
    v_mfma_f32_16x16x32_bf16 v[88:91], v[184:187], v[220:223], v[88:91]
    v_mfma_f32_16x16x32_bf16 v[92:95], v[188:191], v[220:223], v[92:95]
    s_nop 4
    v_cvt_pk_bf16_f32 v108, v80, v81
    v_cvt_pk_bf16_f32 v109, v82, v83
    v_cvt_pk_bf16_f32 v110, v84, v85
    v_cvt_pk_bf16_f32 v111, v86, v87
    v_cvt_pk_bf16_f32 v112, v88, v89
    v_cvt_pk_bf16_f32 v113, v90, v91
    v_cvt_pk_bf16_f32 v114, v92, v93
    v_cvt_pk_bf16_f32 v115, v94, v95
    v_mov_b32 v116, v108
    v_mov_b32 v117, v109
    v_mov_b32 v118, v110
    v_mov_b32 v119, v111
    v_mov_b32_dpp v108, v112 row_ror:8 row_mask:0xf bank_mask:0xc
    v_mov_b32_dpp v109, v113 row_ror:8 row_mask:0xf bank_mask:0xc
    v_mov_b32_dpp v110, v114 row_ror:8 row_mask:0xf bank_mask:0xc
    v_mov_b32_dpp v111, v115 row_ror:8 row_mask:0xf bank_mask:0xc
    buffer_store_dwordx4 v[108:111], v50, s[4:7], s77 offen sc1
    v_mov_b32_dpp v112, v116 row_ror:8 row_mask:0xf bank_mask:0x3
    v_mov_b32_dpp v113, v117 row_ror:8 row_mask:0xf bank_mask:0x3
    v_mov_b32_dpp v114, v118 row_ror:8 row_mask:0xf bank_mask:0x3
    v_mov_b32_dpp v115, v119 row_ror:8 row_mask:0xf bank_mask:0x3
    s_add_u32 s77, s77, 8192
    buffer_store_dwordx4 v[112:115], v50, s[4:7], s77 offen sc1
    s_cmp_ge_u32 s76, 56
    s_cbranch_scc1 FIN
    s_waitcnt vmcnt(0)
    s_barrier
    s_and_b32 s68, s66, 1
    s_lshl_b32 s67, s3, 1
    s_add_u32 s67, s67, s68
    s_mul_i32 s67, s67, 114688
    s_lshl_b32 s69, s64, 3
    s_add_u32 s69, s69, s66
    s_lshl_b32 s69, s69, 6
    s_add_u32 s67, s67, s69
    s_lshl_b32 s68, s68, 11
    s_add_u32 m0, s73, s68
    s_nop 0
    buffer_load_dwordx4 v56, s[28:31], s67 offen lds
    s_add_u32 m0, m0, 1024
    s_add_u32 s67, s67, 57344
    buffer_load_dwordx4 v56, s[28:31], s67 offen lds
    s_lshl_b32 s67, s76, 15
    s_lshl_b32 s68, s3, 7
    s_add_u32 s67, s67, s68
    s_add_u32 m0, s73, 32768
    s_nop 0
    buffer_load_dwordx4 v54, s[32:35], s67 offen nt lds
    s_add_u32 m0, s73, 33792
    s_add_u32 s67, s67, 8192
    buffer_load_dwordx4 v55, s[32:35], s67 offen nt lds
    s_add_u32 m0, s73, 34816
    s_add_u32 s67, s67, 8192
    buffer_load_dwordx4 v54, s[32:35], s67 offen nt lds
    s_add_u32 m0, s73, 35840
    s_add_u32 s67, s67, 8192
    buffer_load_dwordx4 v55, s[32:35], s67 offen nt lds
    s_and_b32 s68, s66, 1
    s_xor_b32 s68, s68, 1
    s_lshl_b32 s67, s3, 1
    s_add_u32 s67, s67, s68
    s_mul_i32 s67, s67, 114688
    s_lshl_b32 s69, s64, 3
    s_add_u32 s69, s69, s66
    s_lshl_b32 s69, s69, 6
    s_add_u32 s67, s67, s69
    s_lshl_b32 s68, s68, 11
    s_add_u32 m0, s73, s68
    s_nop 0
    buffer_load_dwordx4 v56, s[28:31], s67 offen lds
    s_add_u32 m0, m0, 1024
    s_add_u32 s67, s67, 57344
    buffer_load_dwordx4 v56, s[28:31], s67 offen lds
    v_lshrrev_b32 v47, 2, v2
    v_and_b32 v48, 2, v47
    v_and_b32 v49, 1, v3
    v_lshl_or_b32 v48, v49, 2, v48
    v_bfe_u32 v49, v2, 1, 1
    v_or_b32 v48, v48, v49
    v_lshlrev_b32 v48, 4, v48
    v_and_b32 v49, 1, v2
    v_lshl_or_b32 v48, v49, 3, v48
    v_lshl_add_u32 v50, v3, 3, v47
    v_lshl_or_b32 v44, v50, 7, v48
    v_add_u32 v44, s73, v44
    v_xor_b32 v45, 32, v44
    v_xor_b32 v46, 64, v44
    v_xor_b32 v47, 96, v44
    v_and_b32 v49, 1, v3
    v_lshlrev_b32 v60, 4, v2
    v_lshl_or_b32 v60, v49, 3, v60
    v_lshrrev_b32 v49, 1, v3
    v_lshl_or_b32 v60, v49, 8, v60
    v_and_b32 v49, 31, v1
    v_lshlrev_b32 v49, 1, v49
    s_lshl_b32 s67, s76, 6
    s_and_b32 s78, s3, 1
    s_lshl_b32 s68, s78, 10
    s_bfe_u32 s77, s76, 0x10003
    s_lshl_b32 s69, s77, 9
    buffer_load_ushort v40, v49, s[48:51], s67 offen
    buffer_load_dwordx2 v[36:37], v60, s[40:43], s68 offen
    buffer_load_dwordx2 v[38:39], v60, s[40:43], s68 offen offset:512
    buffer_load_dwordx2 v[42:43], v60, s[52:55], s69 offen
    v_lshrrev_b32 v50, 2, v2
    v_lshl_add_u32 v50, v3, 3, v50
    v_and_b32 v48, 3, v2
    v_lshlrev_b32 v48, 3, v48
    v_and_b32 v49, 1, v3
    v_lshl_or_b32 v48, v49, 5, v48
    v_lshl_or_b32 v48, v50, 6, v48
    v_add_u32 v48, s73, v48
    v_xor_b32 v49, 32, v48
    v_and_b32 v41, 1, v2
    v_lshlrev_b32 v50, 10, v41
    v_lshl_or_b32 v50, v3, 4, v50
    s_lshl_b32 s67, s3, 7
    v_add_u32 v50, s67, v50
    v_bfe_u32 v51, v2, 1, 1
    v_lshlrev_b32 v51, 6, v51
    v_lshl_or_b32 v51, v41, 7, v51
    v_lshl_or_b32 v51, v3, 4, v51
    s_lshl_b32 s68, s3, 8
    v_add_u32 v51, s68, v51
    v_lshlrev_b32 v52, 2, v1
    v_lshl_add_u32 v53, v1, 1, s67
    v_lshlrev_b32 v57, 6, v41
    v_lshl_or_b32 v57, v3, 4, v57
    v_add_u32 v57, s67, v57
    v_mul_u32_u24 v58, 57344, v41
    v_lshrrev_b32 v41, 1, v2
    v_lshl_add_u32 v58, v41, 5, v58
    v_lshl_add_u32 v58, v3, 3, v58
    v_lshlrev_b32 v59, 4, v2
    v_lshl_or_b32 v59, v3, 10, v59
    v_mov_b32 v192, 0
    v_mov_b32 v193, 0
    v_mov_b32 v194, 0
    v_mov_b32 v195, 0
    v_mov_b32 v196, 0
    v_mov_b32 v197, 0
    v_mov_b32 v198, 0
    v_mov_b32 v199, 0
    v_mov_b32 v200, 0
    v_mov_b32 v201, 0
    v_mov_b32 v202, 0
    v_mov_b32 v203, 0
    v_mov_b32 v204, 0
    v_mov_b32 v205, 0
    v_mov_b32 v206, 0
    v_mov_b32 v207, 0
    v_mov_b32 v208, 0
    v_mov_b32 v209, 0
    v_mov_b32 v210, 0
    v_mov_b32 v211, 0
    v_mov_b32 v212, 0
    v_mov_b32 v213, 0
    v_mov_b32 v214, 0
    v_mov_b32 v215, 0
    v_mov_b32 v216, 0
    v_mov_b32 v217, 0
    v_mov_b32 v218, 0
    v_mov_b32 v219, 0
    v_mov_b32 v220, 0
    v_mov_b32 v221, 0
    v_mov_b32 v222, 0
    v_mov_b32 v223, 0
    v_cmp_gt_u32 vcc, 8, v2
    v_and_b32 v224, 0x3f803f80, v32
    v_and_b32 v225, 0x3f803f80, v33
    v_and_b32 v226, 0x3f803f80, v34
    v_and_b32 v227, 0x3f803f80, v35
    v_cndmask_b32 v228, 0, v224, vcc
    v_xor_b32 v232, v228, v224
    v_cndmask_b32 v229, 0, v225, vcc
    v_xor_b32 v233, v229, v225
    v_cndmask_b32 v230, 0, v226, vcc
    v_xor_b32 v234, v230, v226
    v_cndmask_b32 v231, 0, v227, vcc
    v_xor_b32 v235, v231, v227
    s_waitcnt vmcnt(0)
    ds_read_b64_tr_b16 v[64:65], v48 offset:0
    ds_read_b64_tr_b16 v[66:67], v48 offset:256
    ds_read_b64_tr_b16 v[68:69], v49 offset:0
    ds_read_b64_tr_b16 v[70:71], v49 offset:256
    ds_read_b64_tr_b16 v[72:73], v48 offset:2048
    ds_read_b64_tr_b16 v[74:75], v48 offset:2304
    ds_read_b64_tr_b16 v[76:77], v49 offset:2048
    ds_read_b64_tr_b16 v[78:79], v49 offset:2304
    ds_read_b64_tr_b16 v[80:81], v44 offset:32768
    ds_read_b64_tr_b16 v[82:83], v44 offset:33280
    ds_read_b64_tr_b16 v[84:85], v45 offset:32768
    ds_read_b64_tr_b16 v[86:87], v45 offset:33280
    ds_read_b64_tr_b16 v[88:89], v46 offset:32768
    ds_read_b64_tr_b16 v[90:91], v46 offset:33280
    ds_read_b64_tr_b16 v[92:93], v47 offset:32768
    ds_read_b64_tr_b16 v[94:95], v47 offset:33280
    s_cmp_ge_u32 s3, 2
    s_cbranch_scc1 MLP_Y
    s_lshl_b32 s68, s3, 12
    s_add_u32 s68, s68, 229376
HML:
    s_add_u32 s67, s68, 0
    buffer_load_dwordx4 v[128:131], v59, s[4:7], s67 offen offset:0 sc1
    buffer_load_dwordx4 v[132:135], v59, s[4:7], s67 offen offset:256 sc1
    buffer_load_dwordx4 v[136:139], v59, s[4:7], s67 offen offset:512 sc1
    buffer_load_dwordx4 v[140:143], v59, s[4:7], s67 offen offset:768 sc1
    s_add_u32 s67, s68, 8192
    buffer_load_dwordx4 v[144:147], v59, s[4:7], s67 offen offset:0 sc1
    buffer_load_dwordx4 v[148:151], v59, s[4:7], s67 offen offset:256 sc1
    buffer_load_dwordx4 v[152:155], v59, s[4:7], s67 offen offset:512 sc1
    buffer_load_dwordx4 v[156:159], v59, s[4:7], s67 offen offset:768 sc1
    s_add_u32 s67, s68, 16384
    buffer_load_dwordx4 v[160:163], v59, s[4:7], s67 offen offset:0 sc1
    buffer_load_dwordx4 v[164:167], v59, s[4:7], s67 offen offset:256 sc1
    buffer_load_dwordx4 v[168:171], v59, s[4:7], s67 offen offset:512 sc1
    buffer_load_dwordx4 v[172:175], v59, s[4:7], s67 offen offset:768 sc1
    s_add_u32 s67, s68, 24576
    buffer_load_dwordx4 v[176:179], v59, s[4:7], s67 offen offset:0 sc1
    buffer_load_dwordx4 v[180:183], v59, s[4:7], s67 offen offset:256 sc1
    buffer_load_dwordx4 v[184:187], v59, s[4:7], s67 offen offset:512 sc1
    buffer_load_dwordx4 v[188:191], v59, s[4:7], s67 offen offset:768 sc1
    s_waitcnt vmcnt(0)
    v_max3_u32 v41, v129, v131, v133
    v_max3_u32 v41, v41, v135, v137
    v_max3_u32 v41, v41, v139, v141
    v_max3_u32 v41, v41, v143, v145
    v_max3_u32 v41, v41, v147, v149
    v_max3_u32 v41, v41, v151, v153
    v_max3_u32 v41, v41, v155, v157
    v_max3_u32 v41, v41, v159, v161
    v_max3_u32 v41, v41, v163, v165
    v_max3_u32 v41, v41, v167, v169
    v_max3_u32 v41, v41, v171, v173
    v_max3_u32 v41, v41, v175, v177
    v_max3_u32 v41, v41, v179, v181
    v_max3_u32 v41, v41, v183, v185
    v_max3_u32 v41, v41, v187, v189
    v_max_u32 v41, v41, v191
    v_cmp_eq_u32 vcc, -1, v41
    s_nop 0
    s_cbranch_vccz HMOK
    s_add_u32 s71, s71, 1
    s_cmp_lt_u32 s71, 65536
    s_cbranch_scc1 HML
HMOK:
    v_mfma_f32_16x16x32_bf16 v[96:99], v[228:231], v[128:131], 0
    v_mfma_f32_16x16x32_bf16 v[96:99], v[232:235], v[132:135], v[96:99]
    v_mfma_f32_16x16x32_bf16 v[100:103], v[228:231], v[136:139], 0
    v_mfma_f32_16x16x32_bf16 v[100:103], v[232:235], v[140:143], v[100:103]
    v_mfma_f32_16x16x32_bf16 v[104:107], v[228:231], v[144:147], 0
    v_mfma_f32_16x16x32_bf16 v[104:107], v[232:235], v[148:151], v[104:107]
    v_mfma_f32_16x16x32_bf16 v[108:111], v[228:231], v[152:155], 0
    v_mfma_f32_16x16x32_bf16 v[108:111], v[232:235], v[156:159], v[108:111]
    v_mfma_f32_16x16x32_bf16 v[112:115], v[228:231], v[160:163], 0
    v_mfma_f32_16x16x32_bf16 v[112:115], v[232:235], v[164:167], v[112:115]
    v_mfma_f32_16x16x32_bf16 v[116:119], v[228:231], v[168:171], 0
    v_mfma_f32_16x16x32_bf16 v[116:119], v[232:235], v[172:175], v[116:119]
    v_mfma_f32_16x16x32_bf16 v[120:123], v[228:231], v[176:179], 0
    v_mfma_f32_16x16x32_bf16 v[120:123], v[232:235], v[180:183], v[120:123]
    v_mfma_f32_16x16x32_bf16 v[124:127], v[228:231], v[184:187], 0
    v_mfma_f32_16x16x32_bf16 v[124:127], v[232:235], v[188:191], v[124:127]
    s_lshl_b32 s68, s3, 14
    s_add_u32 s68, s68, 196608
    v_lshlrev_b32 v240, 16, v36
    v_and_b32 v241, 0xffff0000, v36
    v_lshlrev_b32 v242, 16, v37
    v_and_b32 v243, 0xffff0000, v37
    v_lshlrev_b32 v244, 16, v38
    v_and_b32 v245, 0xffff0000, v38
    v_lshlrev_b32 v246, 16, v39
    v_and_b32 v247, 0xffff0000, v39
    v_add_f32 v112, 1.0, v112
    v_add_f32 v113, 1.0, v113
    v_add_f32 v114, 1.0, v114
    v_add_f32 v115, 1.0, v115
    v_add_f32 v116, 1.0, v116
    v_add_f32 v117, 1.0, v117
    v_add_f32 v118, 1.0, v118
    v_add_f32 v119, 1.0, v119
H5L:
    s_add_u32 s67, s68, 0
    buffer_load_dwordx4 v[128:131], v59, s[4:7], s67 offen offset:0 sc1
    buffer_load_dwordx4 v[132:135], v59, s[4:7], s67 offen offset:256 sc1
    buffer_load_dwordx4 v[136:139], v59, s[4:7], s67 offen offset:512 sc1
    buffer_load_dwordx4 v[140:143], v59, s[4:7], s67 offen offset:768 sc1
    s_add_u32 s67, s68, 4096
    buffer_load_dwordx4 v[144:147], v59, s[4:7], s67 offen offset:0 sc1
    buffer_load_dwordx4 v[148:151], v59, s[4:7], s67 offen offset:256 sc1
    buffer_load_dwordx4 v[152:155], v59, s[4:7], s67 offen offset:512 sc1
    buffer_load_dwordx4 v[156:159], v59, s[4:7], s67 offen offset:768 sc1
    s_add_u32 s67, s68, 8192
    buffer_load_dwordx4 v[160:163], v59, s[4:7], s67 offen offset:0 sc1
    buffer_load_dwordx4 v[164:167], v59, s[4:7], s67 offen offset:256 sc1
    buffer_load_dwordx4 v[168:171], v59, s[4:7], s67 offen offset:512 sc1
    buffer_load_dwordx4 v[172:175], v59, s[4:7], s67 offen offset:768 sc1
    s_add_u32 s67, s68, 12288
    buffer_load_dwordx4 v[176:179], v59, s[4:7], s67 offen offset:0 sc1
    buffer_load_dwordx4 v[180:183], v59, s[4:7], s67 offen offset:256 sc1
    buffer_load_dwordx4 v[184:187], v59, s[4:7], s67 offen offset:512 sc1
    s_add_u32 s67, s68, 12288
    buffer_load_dwordx4 v[188:191], v59, s[4:7], s67 offen offset:768 sc1
H5W:
    s_waitcnt vmcnt(15)
    v_mfma_f32_16x16x32_bf16 v[248:251], v[228:231], v[128:131], 0
    v_max3_u32 v41, v129, v129, v131
    s_waitcnt vmcnt(14)
    v_mfma_f32_16x16x32_bf16 v[248:251], v[232:235], v[132:135], v[248:251]
    v_max3_u32 v41, v41, v133, v135
    s_waitcnt vmcnt(13)
    v_mfma_f32_16x16x32_bf16 v[252:255], v[228:231], v[136:139], 0
    v_max3_u32 v41, v41, v137, v139
    s_waitcnt vmcnt(12)
    v_mfma_f32_16x16x32_bf16 v[252:255], v[232:235], v[140:143], v[252:255]
    v_max3_u32 v41, v41, v141, v143
    s_waitcnt vmcnt(11)
    v_mfma_f32_16x16x32_bf16 v[248:251], v[228:231], v[144:147], v[248:251]
    v_max3_u32 v41, v41, v145, v147
    s_waitcnt vmcnt(10)
    v_mfma_f32_16x16x32_bf16 v[248:251], v[232:235], v[148:151], v[248:251]
    v_max3_u32 v41, v41, v149, v151
    s_waitcnt vmcnt(9)
    v_mfma_f32_16x16x32_bf16 v[252:255], v[228:231], v[152:155], v[252:255]
    v_max3_u32 v41, v41, v153, v155
    s_waitcnt vmcnt(8)
    v_mfma_f32_16x16x32_bf16 v[252:255], v[232:235], v[156:159], v[252:255]
    v_max3_u32 v41, v41, v157, v159
    s_waitcnt vmcnt(7)
    v_mfma_f32_16x16x32_bf16 v[248:251], v[228:231], v[160:163], v[248:251]
    v_max3_u32 v41, v41, v161, v163
    s_waitcnt vmcnt(6)
    v_mfma_f32_16x16x32_bf16 v[248:251], v[232:235], v[164:167], v[248:251]
    v_max3_u32 v41, v41, v165, v167
    s_waitcnt vmcnt(5)
    v_mfma_f32_16x16x32_bf16 v[252:255], v[228:231], v[168:171], v[252:255]
    v_max3_u32 v41, v41, v169, v171
    s_waitcnt vmcnt(4)
    v_mfma_f32_16x16x32_bf16 v[252:255], v[232:235], v[172:175], v[252:255]
    v_max3_u32 v41, v41, v173, v175
    s_waitcnt vmcnt(3)
    v_mfma_f32_16x16x32_bf16 v[248:251], v[228:231], v[176:179], v[248:251]
    v_max3_u32 v41, v41, v177, v179
    s_waitcnt vmcnt(2)
    v_mfma_f32_16x16x32_bf16 v[248:251], v[232:235], v[180:183], v[248:251]
    v_max3_u32 v41, v41, v181, v183
    s_waitcnt vmcnt(1)
    v_mfma_f32_16x16x32_bf16 v[252:255], v[228:231], v[184:187], v[252:255]
    v_max3_u32 v41, v41, v185, v187
    s_waitcnt vmcnt(0)
    v_mfma_f32_16x16x32_bf16 v[252:255], v[232:235], v[188:191], v[252:255]
    v_max3_u32 v41, v41, v189, v191
    v_cmp_eq_u32 vcc, -1, v41
    s_nop 0
    s_cbranch_vccz H5OK
    s_add_u32 s71, s71, 1
    s_cmp_lt_u32 s71, 65536
    s_cbranch_scc1 H5L
H5OK:
    v_fmac_f32 v240, v96, v248
    v_fmac_f32 v241, v97, v249
    v_fmac_f32 v242, v98, v250
    v_fmac_f32 v243, v99, v251
    v_fmac_f32 v244, v100, v252
    v_fmac_f32 v245, v101, v253
    v_fmac_f32 v246, v102, v254
    v_fmac_f32 v247, v103, v255
    v_pk_add_f32 v[36:37], v[240:241], v[242:243]
    v_pk_mul_f32 v[38:39], v[240:241], v[240:241]
    v_pk_fma_f32 v[38:39], v[242:243], v[242:243], v[38:39]
    v_pk_add_f32 v[36:37], v[36:37], v[244:245]
    v_pk_fma_f32 v[38:39], v[244:245], v[244:245], v[38:39]
    v_pk_add_f32 v[36:37], v[36:37], v[246:247]
    v_pk_fma_f32 v[38:39], v[246:247], v[246:247], v[38:39]
    v_add_f32 v36, v36, v37
    v_add_f32 v38, v38, v39
    s_nop 0
    v_add_f32_dpp v36, v36, v36 row_ror:8 row_mask:0xf bank_mask:0xf
    v_add_f32_dpp v38, v38, v38 row_ror:8 row_mask:0xf bank_mask:0xf
    s_nop 0
    v_add_f32_dpp v36, v36, v36 row_ror:4 row_mask:0xf bank_mask:0xf
    v_add_f32_dpp v38, v38, v38 row_ror:4 row_mask:0xf bank_mask:0xf
    s_nop 0
    v_add_f32_dpp v36, v36, v36 row_ror:2 row_mask:0xf bank_mask:0xf
    v_add_f32_dpp v38, v38, v38 row_ror:2 row_mask:0xf bank_mask:0xf
    s_nop 0
    v_add_f32_dpp v36, v36, v36 row_ror:1 row_mask:0xf bank_mask:0xf
    v_add_f32_dpp v38, v38, v38 row_ror:1 row_mask:0xf bank_mask:0xf
    v_mov_b32 v37, v36
    v_mov_b32 v39, v38
    s_nop 0
    v_permlane32_swap_b32 v36, v37
    v_permlane32_swap_b32 v38, v39
    v_add_f32 v36, v36, v37
    v_add_f32 v38, v38, v39
    v_mov_b32 v37, v36
    v_mov_b32 v39, v38
    s_nop 0
    v_permlane16_swap_b32 v36, v37
    v_permlane16_swap_b32 v38, v39
    v_add_f32 v36, v36, v37
    v_add_f32 v38, v38, v39
    v_mul_f32 v36, 0x3b000000, v36
    v_mov_b32 v37, 0x3727c5ac
    v_fmac_f32 v37, 0x3b000000, v38
    v_fma_f32 v37, -v36, v36, v37
    v_rsq_f32 v37, v37
    v_sub_f32 v128, v240, v36
    v_sub_f32 v129, v241, v36
    v_sub_f32 v130, v242, v36
    v_sub_f32 v131, v243, v36
    v_sub_f32 v132, v244, v36
    v_sub_f32 v133, v245, v36
    v_sub_f32 v134, v246, v36
    v_sub_f32 v135, v247, v36
    v_mul_f32 v128, v128, v37
    v_mul_f32 v129, v129, v37
    v_mul_f32 v130, v130, v37
    v_mul_f32 v131, v131, v37
    v_mul_f32 v132, v132, v37
    v_mul_f32 v133, v133, v37
    v_mul_f32 v134, v134, v37
    v_mul_f32 v135, v135, v37
    v_fma_f32 v128, v128, v112, v104
    v_fma_f32 v129, v129, v113, v105
    v_fma_f32 v130, v130, v114, v106
    v_fma_f32 v131, v131, v115, v107
    v_fma_f32 v132, v132, v116, v108
    v_fma_f32 v133, v133, v117, v109
    v_fma_f32 v134, v134, v118, v110
    v_fma_f32 v135, v135, v119, v111
    v_pk_add_f32 v[36:37], v[128:129], v[130:131]
    v_pk_mul_f32 v[38:39], v[128:129], v[128:129]
    v_pk_fma_f32 v[38:39], v[130:131], v[130:131], v[38:39]
    v_pk_add_f32 v[36:37], v[36:37], v[132:133]
    v_pk_fma_f32 v[38:39], v[132:133], v[132:133], v[38:39]
    v_pk_add_f32 v[36:37], v[36:37], v[134:135]
    v_pk_fma_f32 v[38:39], v[134:135], v[134:135], v[38:39]
    v_add_f32 v36, v36, v37
    v_add_f32 v38, v38, v39
    s_nop 0
    v_add_f32_dpp v36, v36, v36 row_ror:8 row_mask:0xf bank_mask:0xf
    v_add_f32_dpp v38, v38, v38 row_ror:8 row_mask:0xf bank_mask:0xf
    s_nop 0
    v_add_f32_dpp v36, v36, v36 row_ror:4 row_mask:0xf bank_mask:0xf
    v_add_f32_dpp v38, v38, v38 row_ror:4 row_mask:0xf bank_mask:0xf
    s_nop 0
    v_add_f32_dpp v36, v36, v36 row_ror:2 row_mask:0xf bank_mask:0xf
    v_add_f32_dpp v38, v38, v38 row_ror:2 row_mask:0xf bank_mask:0xf
    s_nop 0
    v_add_f32_dpp v36, v36, v36 row_ror:1 row_mask:0xf bank_mask:0xf
    v_add_f32_dpp v38, v38, v38 row_ror:1 row_mask:0xf bank_mask:0xf
    v_mov_b32 v37, v36
    v_mov_b32 v39, v38
    s_nop 0
    v_permlane32_swap_b32 v36, v37
    v_permlane32_swap_b32 v38, v39
    v_add_f32 v36, v36, v37
    v_add_f32 v38, v38, v39
    v_mov_b32 v37, v36
    v_mov_b32 v39, v38
    s_nop 0
    v_permlane16_swap_b32 v36, v37
    v_permlane16_swap_b32 v38, v39
    v_add_f32 v36, v36, v37
    v_add_f32 v38, v38, v39
    v_mul_f32 v36, 0x3b000000, v36
    v_mov_b32 v37, 0x3727c5ac
    v_fmac_f32 v37, 0x3b000000, v38
    v_fma_f32 v37, -v36, v36, v37
    v_rsq_f32 v37, v37
    v_sub_f32 v128, v128, v36
    v_sub_f32 v129, v129, v36
    v_sub_f32 v130, v130, v36
    v_sub_f32 v131, v131, v36
    v_sub_f32 v132, v132, v36
    v_sub_f32 v133, v133, v36
    v_sub_f32 v134, v134, v36
    v_sub_f32 v135, v135, v36
    v_mul_f32 v128, v128, v37
    v_mul_f32 v129, v129, v37
    v_mul_f32 v130, v130, v37
    v_mul_f32 v131, v131, v37
    v_mul_f32 v132, v132, v37
    v_mul_f32 v133, v133, v37
    v_mul_f32 v134, v134, v37
    v_mul_f32 v135, v135, v37
    v_cvt_pk_bf16_f32 v128, v128, v129
    v_cvt_pk_bf16_f32 v129, v130, v131
    v_cvt_pk_bf16_f32 v130, v132, v133
    v_cvt_pk_bf16_f32 v131, v134, v135
    s_lshl_b32 s67, s3, 10
    v_add_u32 v41, s67, v60
    ds_write_b64 v41, v[128:129] offset:21504
    ds_write_b64 v41, v[130:131] offset:22016
MLP_Y:
    s_waitcnt lgkmcnt(0)
    s_barrier
    s_mov_b32 exec_lo, 0x30003
    s_mov_b32 exec_hi, 0x30003
    ds_read_b128 v[192:195], v50 offset:21504
    ds_read_b128 v[200:203], v50 offset:21568
    s_mov_b32 exec_lo, 0xc000c
    s_mov_b32 exec_hi, 0xc000c
    ds_read_b128 v[196:199], v50 offset:21504
    ds_read_b128 v[204:207], v50 offset:21568
    s_mov_b64 exec, -1
    s_lshl_b32 s67, s76, 10
    s_lshl_b32 s68, s3, 7
    s_add_u32 s67, s67, s68
    s_add_u32 s67, s67, 327680
    v_lshlrev_b32 v40, 16, v40
    s_waitcnt lgkmcnt(3)
    v_mfma_f32_16x16x32_bf16 v[136:139], v[64:67], v[192:195], 0
    s_waitcnt lgkmcnt(2)
    v_mfma_f32_16x16x32_bf16 v[136:139], v[72:75], v[200:203], v[136:139]
    s_waitcnt lgkmcnt(1)
    v_mfma_f32_16x16x32_bf16 v[136:139], v[68:71], v[196:199], v[136:139]
    s_waitcnt lgkmcnt(0)
    v_mfma_f32_16x16x32_bf16 v[136:139], v[76:79], v[204:207], v[136:139]
    s_mov_b32 exec_lo, 0x000f000f
    s_mov_b32 exec_hi, 0x000f000f
    s_nop 5
    ds_write_b128 v51, v[136:139] offset:0
    s_mov_b64 exec, -1
    s_waitcnt lgkmcnt(0)
    s_barrier
    ds_read2st64_b32 v[136:137], v52 offset0:0 offset1:1
    ds_read2st64_b32 v[138:139], v52 offset0:2 offset1:3
    ds_read2st64_b32 v[140:141], v52 offset0:4 offset1:5
    ds_read2st64_b32 v[142:143], v52 offset0:6 offset1:7
    s_waitcnt lgkmcnt(2)
    v_pk_add_f32 v[136:137], v[136:137], v[138:139]
    s_waitcnt lgkmcnt(0)
    v_pk_add_f32 v[140:141], v[140:141], v[142:143]
    v_add_f32 v136, v136, v40
    v_pk_add_f32 v[136:137], v[136:137], v[140:141]
    v_add_f32 v136, v136, v137
    v_mul_f32 v137, v136, v136
    v_mov_b32 v138, 0xc0135761
    v_fmac_f32 v138, 0xbdd2d3e8, v137
    v_mul_f32 v137, v136, v138
    v_exp_f32 v137, v137
    s_nop 0
    v_add_f32 v137, 1.0, v137
    v_rcp_f32 v137, v137
    s_nop 0
    v_mul_f32 v136, v136, v137
    v_cvt_pk_bf16_f32 v136, v136, v136
    ds_write_b16 v53, v136 offset:23552
    s_mov_b32 exec_lo, 0x30003
    s_mov_b32 exec_hi, 0x30003
    ds_read_b128 v[208:211], v57 offset:23552
    s_mov_b32 exec_lo, 0xc000c
    s_mov_b32 exec_hi, 0xc000c
    ds_read_b128 v[212:215], v57 offset:23552
    s_mov_b32 exec_lo, 0x300030
    s_mov_b32 exec_hi, 0x300030
    ds_read_b128 v[216:219], v57 offset:23552
    s_mov_b32 exec_lo, 0xc000c0
    s_mov_b32 exec_hi, 0xc000c0
    ds_read_b128 v[220:223], v57 offset:23552
    s_mov_b64 exec, -1
    s_waitcnt lgkmcnt(3)
    v_mfma_f32_16x16x32_bf16 v[136:139], v[80:83], v[208:211], 0
    s_waitcnt lgkmcnt(2)
    v_mfma_f32_16x16x32_bf16 v[136:139], v[84:87], v[212:215], v[136:139]
    s_waitcnt lgkmcnt(1)
    v_mfma_f32_16x16x32_bf16 v[136:139], v[88:91], v[216:219], v[136:139]
    s_waitcnt lgkmcnt(0)
    v_mfma_f32_16x16x32_bf16 v[136:139], v[92:95], v[220:223], v[136:139]
    s_nop 7
    v_cvt_pk_bf16_f32 v136, v136, v137
    v_cvt_pk_bf16_f32 v137, v138, v139
    s_mov_b32 exec_lo, 0x00ff00ff
    s_mov_b32 exec_hi, 0x00ff00ff
    buffer_store_dwordx2 v[136:137], v58, s[4:7], s67 offen sc1
    s_mov_b64 exec, -1
    v_lshrrev_b32 v48, 3, v1
    v_and_b32 v49, 7, v1
    v_lshlrev_b32 v49, 4, v49
    v_lshl_or_b32 v48, v48, 10, v49
    s_cmp_ge_u32 s76, 16
    s_cbranch_scc1 FIN
    s_and_b32 s67, s76, 1
    s_cmp_lg_u32 s67, s3
    s_cbranch_scc1 FIN
    s_cmp_eq_u32 s77, 0
    s_cbranch_scc1 F_D0
    v_mov_b32 v240, v244
    v_mov_b32 v120, v124
    v_mov_b32 v241, v245
    v_mov_b32 v121, v125
    v_mov_b32 v242, v246
    v_mov_b32 v122, v126
    v_mov_b32 v243, v247
    v_mov_b32 v123, v127
F_D0:
    v_lshlrev_b32 v244, 16, v42
    v_and_b32 v245, 0xffff0000, v42
    v_lshlrev_b32 v246, 16, v43
    v_and_b32 v247, 0xffff0000, v43
    v_fmac_f32 v240, v120, v244
    v_fmac_f32 v241, v121, v245
    v_fmac_f32 v242, v122, v246
    v_fmac_f32 v243, v123, v247
    s_mul_i32 s68, s3, 57344
    s_lshr_b32 s67, s76, 1
    s_lshl_b32 s69, s67, 7
    s_add_u32 s68, s68, s69
    s_add_u32 s68, s68, 327680
    s_and_b32 s69, s67, 1
    s_lshl_b32 s69, s69, 3
    s_lshl_b32 s69, 0x00ff00ff, s69
    s_bitcmp1_b32 s67, 1
    s_cselect_b32 s74, 0, s69
    s_cselect_b32 s75, s69, 0
    s_lshl_b32 s69, s3, 10
    s_lshl_b32 s70, s77, 9
    s_add_u32 s69, s69, s70
    s_waitcnt vmcnt(0)
H7L:
    s_add_u32 s67, s68, 0
    buffer_load_dwordx4 v[128:131], v48, s[4:7], s67 offen sc1
    s_add_u32 s67, s68, 8192
    buffer_load_dwordx4 v[132:135], v48, s[4:7], s67 offen sc1
    s_add_u32 s67, s68, 16384
    buffer_load_dwordx4 v[136:139], v48, s[4:7], s67 offen sc1
    s_add_u32 s67, s68, 24576
    buffer_load_dwordx4 v[140:143], v48, s[4:7], s67 offen sc1
    s_add_u32 s67, s68, 32768
    buffer_load_dwordx4 v[144:147], v48, s[4:7], s67 offen sc1
    s_add_u32 s67, s68, 40960
    buffer_load_dwordx4 v[148:151], v48, s[4:7], s67 offen sc1
    s_add_u32 s67, s68, 49152
    buffer_load_dwordx4 v[152:155], v48, s[4:7], s67 offen sc1
H7W:
    s_waitcnt vmcnt(6)
    v_mfma_f32_16x16x32_bf16 v[248:251], v[224:227], v[128:131], 0
    v_max3_u32 v41, v129, v129, v131
    s_waitcnt vmcnt(5)
    v_mfma_f32_16x16x32_bf16 v[248:251], v[224:227], v[132:135], v[248:251]
    v_max3_u32 v41, v41, v133, v135
    s_waitcnt vmcnt(4)
    v_mfma_f32_16x16x32_bf16 v[248:251], v[224:227], v[136:139], v[248:251]
    v_max3_u32 v41, v41, v137, v139
    s_waitcnt vmcnt(3)
    v_mfma_f32_16x16x32_bf16 v[248:251], v[224:227], v[140:143], v[248:251]
    v_max3_u32 v41, v41, v141, v143
    s_waitcnt vmcnt(2)
    v_mfma_f32_16x16x32_bf16 v[248:251], v[224:227], v[144:147], v[248:251]
    v_max3_u32 v41, v41, v145, v147
    s_waitcnt vmcnt(1)
    v_mfma_f32_16x16x32_bf16 v[248:251], v[224:227], v[148:151], v[248:251]
    v_max3_u32 v41, v41, v149, v151
    s_waitcnt vmcnt(0)
    v_mfma_f32_16x16x32_bf16 v[248:251], v[224:227], v[152:155], v[248:251]
    v_max3_u32 v41, v41, v153, v155
    v_cmp_eq_u32 vcc, -1, v41
    s_nop 0
    s_cbranch_vccz H7OK
    s_add_u32 s71, s71, 1
    s_cmp_lt_u32 s71, 65536
    s_cbranch_scc1 H7L
H7OK:
    s_nop 3
    v_add_f32_dpp v248, v248, v248 row_ror:8 row_mask:0xf bank_mask:0xf
    v_add_f32_dpp v249, v249, v249 row_ror:8 row_mask:0xf bank_mask:0xf
    v_add_f32_dpp v250, v250, v250 row_ror:8 row_mask:0xf bank_mask:0xf
    v_add_f32_dpp v251, v251, v251 row_ror:8 row_mask:0xf bank_mask:0xf
    v_fmac_f32 v240, v120, v248
    v_fmac_f32 v241, v121, v249
    v_fmac_f32 v242, v122, v250
    v_fmac_f32 v243, v123, v251
    v_cvt_pk_bf16_f32 v240, v240, v241
    v_cvt_pk_bf16_f32 v241, v242, v243
    s_mov_b64 exec, s[74:75]
    buffer_store_dwordx2 v[240:241], v60, s[56:59], s69 offen
    s_branch FIN
BPATH:
    s_lshl_b32 s76, s64, 2
    s_lshr_b32 s67, s66, 2
    s_add_u32 s76, s76, s67
    s_and_b32 s77, s66, 3
    v_lshlrev_b32 v44, 4, v2
    v_lshl_or_b32 v44, v3, 16, v44
    s_lshl_b32 s67, s3, 19
    s_lshl_b32 s68, s76, 8
    s_add_u32 s67, s67, s68
    s_lshl_b32 s69, s77, 17
    s_and_b32 s69, s69, 0x40000
    s_add_u32 s67, s67, s69
    s_lshl_b32 s69, s77, 3
    s_add_u32 s69, s69, s3
    s_lshl_b32 s69, s69, 17
    s_add_u32 s68, s68, s69
    v_lshl_add_u32 v48, v3, 13, v36
    v_xor_b32 v49, 32800, v48
    v_xor_b32 v50, 65664, v48
    v_xor_b32 v51, 98464, v48
    s_mov_b32 s14, 4194304
    s_mov_b32 s15, 0x00020000
    s_mov_b32 s18, 4194304
    s_mov_b32 s19, 0x00020000
    v_lshlrev_b32 v45, 4, v2
    v_lshl_or_b32 v45, v3, 14, v45
    s_and_b32 s65, s76, 16
    s_add_u32 s65, s65, s3
    s_lshl_b32 s78, s65, 7
    s_and_b32 s70, s76, 15
    s_add_u32 s78, s78, s70
    s_lshl_b32 s72, s78, 3
    s_lshl_b32 s78, s78, 2
    s_add_u32 s78, s78, s77
    s_lshl_b32 s78, s78, 8
    s_add_u32 s78, s78, 1048576
    s_add_u32 s72, s72, 262144
    s_bitcmp1_b32 s77, 0
    s_waitcnt lgkmcnt(0)
    s_cbranch_scc1 BQ1
    s_xor_b32 s70, s67, 0
    buffer_load_dwordx4 v[64:67], v44, s[12:15], s70 offen
    s_xor_b32 s70, s67, 8192
    buffer_load_dwordx4 v[68:71], v44, s[12:15], s70 offen
    s_xor_b32 s70, s67, 16384
    buffer_load_dwordx4 v[72:75], v44, s[12:15], s70 offen
    s_xor_b32 s70, s67, 24576
    buffer_load_dwordx4 v[76:79], v44, s[12:15], s70 offen
    s_add_u32 m0, s73, 0
    s_nop 0
    buffer_load_dwordx4 v48, s[16:19], s68 offen nt lds
    s_add_u32 m0, s73, 1024
    s_nop 0
    buffer_load_dwordx4 v49, s[16:19], s68 offen nt lds
    s_add_u32 m0, s73, 2048
    s_nop 0
    buffer_load_dwordx4 v50, s[16:19], s68 offen nt lds
    s_add_u32 m0, s73, 3072
    s_nop 0
    buffer_load_dwordx4 v51, s[16:19], s68 offen nt lds
    s_xor_b32 s70, s67, 32768
    buffer_load_dwordx4 v[80:83], v44, s[12:15], s70 offen
    s_xor_b32 s70, s67, 40960
    buffer_load_dwordx4 v[84:87], v44, s[12:15], s70 offen
    s_xor_b32 s70, s67, 49152
    buffer_load_dwordx4 v[88:91], v44, s[12:15], s70 offen
    s_xor_b32 s70, s67, 57344
    buffer_load_dwordx4 v[92:95], v44, s[12:15], s70 offen
    s_cmp_eq_u32 s3, 7
    s_cselect_b64 exec, 1, 0
    buffer_load_dword v63, v62, s[60:63], 0 offen offset:128 sc1
    s_mov_b64 exec, -1
    s_xor_b32 s70, s67, 262144
    buffer_load_dwordx4 v[96:99], v44, s[12:15], s70 offen
    s_xor_b32 s70, s67, 270336
    buffer_load_dwordx4 v[100:103], v44, s[12:15], s70 offen
    s_xor_b32 s70, s67, 278528
    buffer_load_dwordx4 v[104:107], v44, s[12:15], s70 offen
    s_xor_b32 s70, s67, 286720
    buffer_load_dwordx4 v[108:111], v44, s[12:15], s70 offen
    s_xor_b32 s70, s67, 294912
    buffer_load_dwordx4 v[112:115], v44, s[12:15], s70 offen
    s_xor_b32 s70, s67, 303104
    buffer_load_dwordx4 v[116:119], v44, s[12:15], s70 offen
    s_xor_b32 s70, s67, 311296
    buffer_load_dwordx4 v[120:123], v44, s[12:15], s70 offen
    s_xor_b32 s70, s67, 319488
    buffer_load_dwordx4 v[124:127], v44, s[12:15], s70 offen
    s_branch BQ2
BQ1:
    s_xor_b32 s70, s67, 32768
    buffer_load_dwordx4 v[80:83], v44, s[12:15], s70 offen
    s_xor_b32 s70, s67, 40960
    buffer_load_dwordx4 v[84:87], v44, s[12:15], s70 offen
    s_xor_b32 s70, s67, 49152
    buffer_load_dwordx4 v[88:91], v44, s[12:15], s70 offen
    s_xor_b32 s70, s67, 57344
    buffer_load_dwordx4 v[92:95], v44, s[12:15], s70 offen
    s_add_u32 m0, s73, 0
    s_nop 0
    buffer_load_dwordx4 v48, s[16:19], s68 offen nt lds
    s_add_u32 m0, s73, 1024
    s_nop 0
    buffer_load_dwordx4 v49, s[16:19], s68 offen nt lds
    s_add_u32 m0, s73, 2048
    s_nop 0
    buffer_load_dwordx4 v50, s[16:19], s68 offen nt lds
    s_add_u32 m0, s73, 3072
    s_nop 0
    buffer_load_dwordx4 v51, s[16:19], s68 offen nt lds
    s_xor_b32 s70, s67, 0
    buffer_load_dwordx4 v[64:67], v44, s[12:15], s70 offen
    s_xor_b32 s70, s67, 8192
    buffer_load_dwordx4 v[68:71], v44, s[12:15], s70 offen
    s_xor_b32 s70, s67, 16384
    buffer_load_dwordx4 v[72:75], v44, s[12:15], s70 offen
    s_xor_b32 s70, s67, 24576
    buffer_load_dwordx4 v[76:79], v44, s[12:15], s70 offen
    s_cmp_eq_u32 s3, 7
    s_cselect_b64 exec, 1, 0
    buffer_load_dword v63, v62, s[60:63], 0 offen offset:128 sc1
    s_mov_b64 exec, -1
    s_xor_b32 s70, s67, 294912
    buffer_load_dwordx4 v[112:115], v44, s[12:15], s70 offen
    s_xor_b32 s70, s67, 303104
    buffer_load_dwordx4 v[116:119], v44, s[12:15], s70 offen
    s_xor_b32 s70, s67, 311296
    buffer_load_dwordx4 v[120:123], v44, s[12:15], s70 offen
    s_xor_b32 s70, s67, 319488
    buffer_load_dwordx4 v[124:127], v44, s[12:15], s70 offen
    s_xor_b32 s70, s67, 262144
    buffer_load_dwordx4 v[96:99], v44, s[12:15], s70 offen
    s_xor_b32 s70, s67, 270336
    buffer_load_dwordx4 v[100:103], v44, s[12:15], s70 offen
    s_xor_b32 s70, s67, 278528
    buffer_load_dwordx4 v[104:107], v44, s[12:15], s70 offen
    s_xor_b32 s70, s67, 286720
    buffer_load_dwordx4 v[108:111], v44, s[12:15], s70 offen
BQ2:
    s_and_b32 s79, s3, 1
    s_and_b32 s67, s3, 2
    s_lshl_b32 s67, s67, 1
    s_or_b32 s79, s79, s67
    s_and_b32 s67, s3, 4
    s_lshr_b32 s67, s67, 1
    s_or_b32 s79, s79, s67
    v_and_b32 v37, 9, v2
    v_and_b32 v38, 2, v2
    v_lshl_or_b32 v37, v38, 1, v37
    v_bfe_u32 v38, v2, 2, 1
    v_lshl_or_b32 v37, v38, 1, v37
    v_xor_b32 v38, v37, v3
    v_lshlrev_b32 v38, 4, v38
    v_lshl_or_b32 v4, v2, 8, v38
    v_xor_b32 v5, 64, v4
    v_xor_b32 v6, 128, v4
    v_xor_b32 v7, 192, v4
    v_add_u32 v8, s73, v4
    v_add_u32 v9, s73, v5
    v_add_u32 v10, s73, v6
    v_add_u32 v11, s73, v7
    s_lshl_b32 s67, s3, 1
    v_lshrrev_b32 v38, 1, v3
    v_or_b32 v38, s67, v38
    v_xor_b32 v38, v38, v37
    v_lshlrev_b32 v38, 4, v38
    v_lshl_or_b32 v38, v2, 8, v38
    v_and_b32 v39, 1, v3
    v_lshl_or_b32 v61, v39, 3, v38
    v_and_b32 v38, 1, v2
    v_lshlrev_b32 v38, 4, v38
    v_mov_b32 v39, 0xffff
    v_lshlrev_b32 v39, v38, v39
    v_bfe_u32 v38, v2, 1, 2
    v_cmp_eq_u32 vcc, 0, v38
    s_nop 1
    v_cndmask_b32 v32, 0, v39, vcc
    v_cmp_eq_u32 vcc, 1, v38
    s_nop 1
    v_cndmask_b32 v33, 0, v39, vcc
    v_cmp_eq_u32 vcc, 2, v38
    s_nop 1
    v_cndmask_b32 v34, 0, v39, vcc
    v_cmp_eq_u32 vcc, 3, v38
    s_nop 1
    v_cndmask_b32 v35, 0, v39, vcc
    s_mov_b32 s22, 4194304
    s_mov_b32 s23, 0x00020000
    s_mov_b32 s26, 4194304
    s_mov_b32 s27, 0x00020000
    s_mov_b32 s38, 3145728
    s_mov_b32 s39, 0x00020000
    s_mov_b32 s46, 2048
    s_mov_b32 s47, 0x00020000
    v_and_b32 v46, 7, v2
    v_lshlrev_b32 v46, 10, v46
    v_lshl_or_b32 v46, v3, 4, v46
    s_lshl_b32 s69, s3, 7
    s_lshl_b32 s70, s77, 5
    s_and_b32 s70, s70, 64
    s_or_b32 s69, s69, s70
    s_xor_b32 s70, s69, 64
    v_and_b32 v47, 1, v3
    v_lshlrev_b32 v47, 3, v47
    v_or_b32 v52, s79, v47
    v_xor_b32 v52, v52, v2
    v_or_b32 v47, s3, v47
    v_lshlrev_b32 v47, 8, v47
    v_lshl_or_b32 v47, v52, 4, v47
    v_lshrrev_b32 v53, 3, v2
    v_lshlrev_b32 v53, 15, v53
    v_lshl_or_b32 v53, v3, 3, v53
    v_lshrrev_b32 v252, 3, v2
    v_lshlrev_b32 v252, 8, v252
    v_lshl_or_b32 v252, v3, 3, v252
    s_lshl_b32 s100, s3, 5
    v_add_u32 v252, s100, v252
    v_lshlrev_b32 v253, 4, v1
    s_mov_b32 s100, 0x05040100
    s_mov_b32 s101, 0x07060302
    s_waitcnt vmcnt(8)
    s_cmp_lg_u32 s3, 7
    s_cbranch_scc1 BC_OK
BC_CK:
    v_readfirstlane_b32 s74, v63
    s_cmp_lg_u32 s74, 0
    s_cbranch_scc1 BC_OK
    s_cmp_eq_u32 s3, 7
    s_cselect_b64 exec, 1, 0
    buffer_load_dword v63, v62, s[60:63], 0 offen offset:128 sc1
    s_mov_b64 exec, -1
    s_add_u32 s71, s71, 1
    s_cmp_lt_u32 s71, 65536
    s_waitcnt vmcnt(0)
    s_cbranch_scc1 BC_CK
BC_OK:
    s_barrier
    buffer_load_dwordx4 v[36:39], v46, s[4:7], s69 offen sc1
    buffer_load_dwordx4 v[240:243], v46, s[4:7], s70 offen sc1
    ds_read_b128 v[192:195], v8
    ds_read_b128 v[196:199], v9
    ds_read_b128 v[200:203], v10
    ds_read_b128 v[204:207], v11
    v_perm_b32 v128, v68, v64, s100
    v_perm_b32 v129, v76, v72, s100
    v_perm_b32 v130, v84, v80, s100
    v_perm_b32 v131, v92, v88, s100
    v_perm_b32 v132, v68, v64, s101
    v_perm_b32 v133, v76, v72, s101
    v_perm_b32 v134, v84, v80, s101
    v_perm_b32 v135, v92, v88, s101
    v_perm_b32 v136, v69, v65, s100
    v_perm_b32 v137, v77, v73, s100
    v_perm_b32 v138, v85, v81, s100
    v_perm_b32 v139, v93, v89, s100
    v_perm_b32 v140, v69, v65, s101
    v_perm_b32 v141, v77, v73, s101
    v_perm_b32 v142, v85, v81, s101
    v_perm_b32 v143, v93, v89, s101
    v_perm_b32 v144, v70, v66, s100
    v_perm_b32 v145, v78, v74, s100
    v_perm_b32 v146, v86, v82, s100
    v_perm_b32 v147, v94, v90, s100
    v_perm_b32 v148, v70, v66, s101
    v_perm_b32 v149, v78, v74, s101
    v_perm_b32 v150, v86, v82, s101
    v_perm_b32 v151, v94, v90, s101
    v_perm_b32 v152, v71, v67, s100
    v_perm_b32 v153, v79, v75, s100
    v_perm_b32 v154, v87, v83, s100
    v_perm_b32 v155, v95, v91, s100
    v_perm_b32 v156, v71, v67, s101
    v_perm_b32 v157, v79, v75, s101
    v_perm_b32 v158, v87, v83, s101
    v_perm_b32 v159, v95, v91, s101
    s_waitcnt vmcnt(2)
    v_perm_b32 v160, v100, v96, s100
    v_perm_b32 v161, v108, v104, s100
    v_perm_b32 v162, v116, v112, s100
    v_perm_b32 v163, v124, v120, s100
    v_perm_b32 v164, v100, v96, s101
    v_perm_b32 v165, v108, v104, s101
    v_perm_b32 v166, v116, v112, s101
    v_perm_b32 v167, v124, v120, s101
    v_perm_b32 v168, v101, v97, s100
    v_perm_b32 v169, v109, v105, s100
    v_perm_b32 v170, v117, v113, s100
    v_perm_b32 v171, v125, v121, s100
    v_perm_b32 v172, v101, v97, s101
    v_perm_b32 v173, v109, v105, s101
    v_perm_b32 v174, v117, v113, s101
    v_perm_b32 v175, v125, v121, s101
    v_perm_b32 v176, v102, v98, s100
    v_perm_b32 v177, v110, v106, s100
    v_perm_b32 v178, v118, v114, s100
    v_perm_b32 v179, v126, v122, s100
    v_perm_b32 v180, v102, v98, s101
    v_perm_b32 v181, v110, v106, s101
    v_perm_b32 v182, v118, v114, s101
    v_perm_b32 v183, v126, v122, s101
    v_perm_b32 v184, v103, v99, s100
    v_perm_b32 v185, v111, v107, s100
    v_perm_b32 v186, v119, v115, s100
    v_perm_b32 v187, v127, v123, s100
    v_perm_b32 v188, v103, v99, s101
    v_perm_b32 v189, v111, v107, s101
    v_perm_b32 v190, v119, v115, s101
    v_perm_b32 v191, v127, v123, s101
    s_branch H1W
H1L:
    buffer_load_dwordx4 v[36:39], v46, s[4:7], s69 offen sc1
    buffer_load_dwordx4 v[240:243], v46, s[4:7], s70 offen sc1
H1W:
    s_waitcnt vmcnt(0)
    v_max3_u32 v52, v37, v39, v241
    v_max_u32 v52, v52, v243
    v_cmp_eq_u32 vcc, -1, v52
    s_nop 0
    s_cbranch_vccz H1OK
    s_add_u32 s71, s71, 1
    s_cmp_lt_u32 s71, 65536
    s_cbranch_scc1 H1L
H1OK:
    v_mfma_f32_16x16x32_bf16 v[208:211], v[36:39], v[128:131], 0
    v_mfma_f32_16x16x32_bf16 v[212:215], v[36:39], v[132:135], 0
    v_mfma_f32_16x16x32_bf16 v[216:219], v[36:39], v[136:139], 0
    v_mfma_f32_16x16x32_bf16 v[220:223], v[36:39], v[140:143], 0
    v_mfma_f32_16x16x32_bf16 v[224:227], v[36:39], v[144:147], 0
    v_mfma_f32_16x16x32_bf16 v[228:231], v[36:39], v[148:151], 0
    v_mfma_f32_16x16x32_bf16 v[232:235], v[36:39], v[152:155], 0
    v_mfma_f32_16x16x32_bf16 v[236:239], v[36:39], v[156:159], 0
    v_mfma_f32_16x16x32_bf16 v[208:211], v[240:243], v[160:163], v[208:211]
    v_mfma_f32_16x16x32_bf16 v[212:215], v[240:243], v[164:167], v[212:215]
    v_mfma_f32_16x16x32_bf16 v[216:219], v[240:243], v[168:171], v[216:219]
    v_mfma_f32_16x16x32_bf16 v[220:223], v[240:243], v[172:175], v[220:223]
    v_mfma_f32_16x16x32_bf16 v[224:227], v[240:243], v[176:179], v[224:227]
    v_mfma_f32_16x16x32_bf16 v[228:231], v[240:243], v[180:183], v[228:231]
    v_mfma_f32_16x16x32_bf16 v[232:235], v[240:243], v[184:187], v[232:235]
    v_mfma_f32_16x16x32_bf16 v[236:239], v[240:243], v[188:191], v[236:239]
    s_waitcnt lgkmcnt(0)
    v_pk_add_f32 v[208:209], v[208:209], v[210:211]
    v_pk_add_f32 v[212:213], v[212:213], v[214:215]
    v_pk_add_f32 v[216:217], v[216:217], v[218:219]
    v_pk_add_f32 v[220:221], v[220:221], v[222:223]
    v_pk_add_f32 v[224:225], v[224:225], v[226:227]
    v_pk_add_f32 v[228:229], v[228:229], v[230:231]
    v_pk_add_f32 v[232:233], v[232:233], v[234:235]
    v_pk_add_f32 v[236:237], v[236:237], v[238:239]
    v_add_f32 v208, v208, v209
    v_add_f32 v212, v212, v213
    v_add_f32 v216, v216, v217
    v_add_f32 v220, v220, v221
    v_add_f32 v224, v224, v225
    v_add_f32 v228, v228, v229
    v_add_f32 v232, v232, v233
    v_add_f32 v236, v236, v237
    v_cvt_pk_bf16_f32 v56, v208, v212
    v_cvt_pk_bf16_f32 v57, v216, v220
    v_cvt_pk_bf16_f32 v58, v224, v228
    v_cvt_pk_bf16_f32 v59, v232, v236
    s_mov_b32 exec_hi, 0
    ds_write_b128 v47, v[56:59] offset:16384
    s_mov_b64 exec, -1
    s_waitcnt lgkmcnt(0)
    s_barrier
    ds_read_b128 v[64:67], v4 offset:16384
    ds_read_b128 v[68:71], v5 offset:16384
    ds_read_b128 v[72:75], v6 offset:16384
    ds_read_b128 v[76:79], v7 offset:16384
    s_lshl_b32 s67, s76, 10
    s_lshl_b32 s68, s77, 8
    s_add_u32 s67, s67, s68
    s_lshl_b32 s68, s3, 5
    s_add_u32 s67, s67, s68
    s_add_u32 s67, s67, 65536
    s_waitcnt lgkmcnt(3)
    v_mfma_f32_16x16x32_bf16 v[208:211], v[192:195], v[64:67], 0
    s_waitcnt lgkmcnt(2)
    v_mfma_f32_16x16x32_bf16 v[208:211], v[196:199], v[68:71], v[208:211]
    s_waitcnt lgkmcnt(1)
    v_mfma_f32_16x16x32_bf16 v[208:211], v[200:203], v[72:75], v[208:211]
    s_waitcnt lgkmcnt(0)
    v_mfma_f32_16x16x32_bf16 v[208:211], v[204:207], v[76:79], v[208:211]
    s_nop 7
    v_add_f32_dpp v208, v208, v208 quad_perm:[1,0,3,2] row_mask:0xf bank_mask:0xf
    v_add_f32_dpp v209, v209, v209 quad_perm:[1,0,3,2] row_mask:0xf bank_mask:0xf
    v_add_f32_dpp v210, v210, v210 quad_perm:[1,0,3,2] row_mask:0xf bank_mask:0xf
    v_add_f32_dpp v211, v211, v211 quad_perm:[1,0,3,2] row_mask:0xf bank_mask:0xf
    v_add_f32_dpp v208, v208, v208 quad_perm:[2,3,0,1] row_mask:0xf bank_mask:0xf
    v_add_f32_dpp v209, v209, v209 quad_perm:[2,3,0,1] row_mask:0xf bank_mask:0xf
    v_add_f32_dpp v210, v210, v210 quad_perm:[2,3,0,1] row_mask:0xf bank_mask:0xf
    v_add_f32_dpp v211, v211, v211 quad_perm:[2,3,0,1] row_mask:0xf bank_mask:0xf
    v_add_f32_dpp v208, v208, v208 row_half_mirror row_mask:0xf bank_mask:0xf
    v_add_f32_dpp v209, v209, v209 row_half_mirror row_mask:0xf bank_mask:0xf
    v_add_f32_dpp v210, v210, v210 row_half_mirror row_mask:0xf bank_mask:0xf
    v_add_f32_dpp v211, v211, v211 row_half_mirror row_mask:0xf bank_mask:0xf
    v_mul_f32 v208, 0x3e0293ee, v208
    v_mul_f32 v209, 0x3e0293ee, v209
    v_mul_f32 v210, 0x3e0293ee, v210
    v_mul_f32 v211, 0x3e0293ee, v211
    v_cvt_pk_bf16_f32 v208, v208, v209
    v_cvt_pk_bf16_f32 v209, v210, v211
    s_mov_b32 exec_lo, 0x01010101
    s_mov_b32 exec_hi, 0x01010101
    ds_write_b64 v252, v[208:209] offset:20480
    s_mov_b64 exec, -1
    v_lshlrev_b32 v254, 15, v3
    v_lshl_or_b32 v254, v2, 4, v254
    s_cmp_lg_u32 s3, 0
    s_waitcnt lgkmcnt(0)
    s_barrier
    s_cbranch_scc1 P3_E
    s_mov_b32 exec_hi, 0
    ds_read_b128 v[208:211], v253 offset:20480
    s_waitcnt lgkmcnt(0)
    buffer_store_dwordx4 v[208:211], v254, s[4:7], s67 offen sc1
P3_E:
    s_mov_b64 exec, -1
    v_lshlrev_b32 v47, 4, v2
    v_lshl_or_b32 v48, v3, 13, v47
    s_lshl_b32 s68, s77, 3
    s_add_u32 s68, s68, s3
    s_lshl_b32 s68, s68, 17
    s_lshl_b32 s69, s76, 8
    s_add_u32 s68, s68, s69
    buffer_load_dwordx4 v[192:195], v48, s[20:23], s68 offen nt
    s_add_u32 s68, s68, 32768
    buffer_load_dwordx4 v[196:199], v48, s[20:23], s68 offen nt
    s_add_u32 s68, s68, 32768
    buffer_load_dwordx4 v[200:203], v48, s[20:23], s68 offen nt
    s_add_u32 s68, s68, 32768
    buffer_load_dwordx4 v[204:207], v48, s[20:23], s68 offen nt
    v_lshrrev_b32 v46, 3, v1
    v_and_b32 v47, 2, v46
    v_and_b32 v54, 7, v1
    v_xor_b32 v54, v54, v47
    v_lshlrev_b32 v54, 4, v54
    v_lshl_or_b32 v54, v46, 10, v54
    v_xor_b32 v55, 64, v54
    v_mul_u32_u24 v57, 24576, v3
    v_lshl_add_u32 v57, v2, 4, v57
    v_lshrrev_b32 v58, 3, v2
    v_lshlrev_b32 v58, 10, v58
    v_lshl_or_b32 v58, v3, 3, v58
    s_lshl_b32 s73, s3, 12
    s_add_u32 s73, s73, 65536
    s_lshl_b32 s67, s64, 1
    s_lshr_b32 s68, s66, 3
    s_add_u32 s67, s67, s68
    s_lshl_b32 s67, s67, 3
    s_add_u32 s67, s67, s3
    s_lshl_b32 s67, s67, 15
    s_and_b32 s68, s66, 7
    s_lshl_b32 s68, s68, 7
    s_add_u32 s67, s67, s68
    s_add_u32 m0, s73, 0
    s_nop 0
    buffer_load_dwordx4 v54, s[24:27], s67 offen nt lds
    s_add_u32 m0, s73, 1024
    s_add_u32 s67, s67, 8192
    buffer_load_dwordx4 v55, s[24:27], s67 offen nt lds
    s_add_u32 m0, s73, 2048
    s_add_u32 s67, s67, 8192
    buffer_load_dwordx4 v54, s[24:27], s67 offen nt lds
    s_add_u32 m0, s73, 3072
    s_add_u32 s67, s67, 8192
    buffer_load_dwordx4 v55, s[24:27], s67 offen nt lds
    v_lshlrev_b32 v44, 1, v3
    v_xor_b32 v44, v44, v2
    v_lshlrev_b32 v44, 4, v44
    v_lshl_or_b32 v44, v3, 8, v44
    s_lshl_b32 s67, s3, 12
    s_add_u32 s67, s67, 32768
    v_add_u32 v60, s67, v44
    v_xor_b32 v59, 2176, v60
    s_cmp_lt_u32 s66, 8
    s_cbranch_scc1 NOHM
    s_and_b32 s67, s66, 3
    s_lshl_b32 s67, s67, 3
    s_add_u32 s67, s67, s3
    s_lshl_b32 s68, s67, 5
    s_mul_i32 s67, s67, 98304
    s_lshl_b32 s69, s64, 1
    s_bfe_u32 s70, s66, 0x10002
    s_add_u32 s69, s69, s70
    s_lshl_b32 s69, s69, 8
    s_add_u32 s67, s67, s69
    s_add_u32 s67, s67, 2048
    buffer_load_dwordx2 v[112:113], v58, s[44:47], s68 offen
    buffer_load_dwordx4 v[96:99], v57, s[36:39], s67 offen nt
    s_add_u32 s67, s67, 6144
    buffer_load_dwordx4 v[100:103], v57, s[36:39], s67 offen nt
    s_add_u32 s67, s67, 6144
    buffer_load_dwordx4 v[104:107], v57, s[36:39], s67 offen nt
    s_add_u32 s67, s67, 6144
    buffer_load_dwordx4 v[108:111], v57, s[36:39], s67 offen nt
    s_waitcnt vmcnt(9)
    ds_write_b128 v60, v[192:195] offset:0
    ds_write_b128 v60, v[196:199] offset:1024
    ds_write_b128 v59, v[200:203] offset:0
    ds_write_b128 v59, v[204:207] offset:1024
    s_waitcnt vmcnt(0)
    v_mov_b32 v59, v45
    v_lshlrev_b32 v64, 16, v112
    v_and_b32 v65, 0xffff0000, v112
    v_lshlrev_b32 v66, 16, v113
    v_and_b32 v67, 0xffff0000, v113
    v_mul_f32 v68, 0xbfb8aa3b, v64
    v_mul_f32 v69, 0xbfb8aa3b, v65
    v_mul_f32 v70, 0xbfb8aa3b, v66
    v_mul_f32 v71, 0xbfb8aa3b, v67
    v_exp_f32 v68, v68
    v_exp_f32 v69, v69
    v_exp_f32 v70, v70
    v_exp_f32 v71, v71
    v_add_f32 v68, 1.0, v68
    v_add_f32 v69, 1.0, v69
    v_add_f32 v70, 1.0, v70
    v_add_f32 v71, 1.0, v71
    v_rcp_f32 v68, v68
    v_rcp_f32 v69, v69
    v_rcp_f32 v70, v70
    v_rcp_f32 v71, v71
    v_mul_f32 v64, v64, v68
    v_mul_f32 v65, v65, v69
    v_mul_f32 v66, v66, v70
    v_mul_f32 v67, v67, v71
    v_cvt_pk_bf16_f32 v64, v64, v64
    v_cvt_pk_bf16_f32 v65, v65, v65
    v_cvt_pk_bf16_f32 v66, v66, v66
    v_cvt_pk_bf16_f32 v67, v67, v67
    v_and_b32 v128, v64, v32
    v_and_b32 v129, v64, v33
    v_and_b32 v130, v64, v34
    v_and_b32 v131, v64, v35
    v_and_b32 v132, v65, v32
    v_and_b32 v133, v65, v33
    v_and_b32 v134, v65, v34
    v_and_b32 v135, v65, v35
    v_and_b32 v136, v66, v32
    v_and_b32 v137, v66, v33
    v_and_b32 v138, v66, v34
    v_and_b32 v139, v66, v35
    v_and_b32 v140, v67, v32
    v_and_b32 v141, v67, v33
    v_and_b32 v142, v67, v34
    v_and_b32 v143, v67, v35
    s_lshl_b32 s69, s64, 1
    s_bfe_u32 s70, s66, 0x10002
    s_add_u32 s69, s69, s70
    s_lshr_b32 s70, s69, 2
    s_lshl_b32 s70, s70, 13
    s_and_b32 s69, s69, 3
    s_lshl_b32 s69, s69, 8
    s_add_u32 s70, s70, s69
    s_and_b32 s69, s66, 3
    s_lshl_b32 s69, s69, 10
    s_add_u32 s70, s70, s69
    s_add_u32 s70, s70, 229376
    v_and_b32 v49, 1, v3
    v_lshlrev_b32 v50, 4, v2
    v_lshl_or_b32 v50, v49, 3, v50
    v_lshrrev_b32 v49, 1, v3
    v_lshl_or_b32 v50, v49, 12, v50
    v_mfma_f32_16x16x32_bf16 v[208:211], v[128:131], v[96:99], 0
    v_mfma_f32_16x16x32_bf16 v[208:211], v[132:135], v[100:103], v[208:211]
    v_mfma_f32_16x16x32_bf16 v[208:211], v[136:139], v[104:107], v[208:211]
    v_mfma_f32_16x16x32_bf16 v[208:211], v[140:143], v[108:111], v[208:211]
    s_lshl_b32 s67, s3, 10
    v_lshlrev_b32 v44, 4, v1
    v_add_u32 v45, s67, v44
    s_nop 4
    ds_write_b128 v45, v[208:211] offset:0
    s_waitcnt lgkmcnt(0)
    s_barrier
    s_cmp_lg_u32 s3, 0
    s_cbranch_scc1 HMDONE
    ds_read_b128 v[64:67], v44 offset:0
    ds_read_b128 v[68:71], v44 offset:1024
    ds_read_b128 v[72:75], v44 offset:2048
    ds_read_b128 v[76:79], v44 offset:3072
    ds_read_b128 v[80:83], v44 offset:4096
    ds_read_b128 v[84:87], v44 offset:5120
    ds_read_b128 v[88:91], v44 offset:6144
    ds_read_b128 v[92:95], v44 offset:7168
    s_waitcnt lgkmcnt(6)
    v_pk_add_f32 v[64:65], v[64:65], v[68:69]
    v_pk_add_f32 v[66:67], v[66:67], v[70:71]
    s_waitcnt lgkmcnt(4)
    v_pk_add_f32 v[72:73], v[72:73], v[76:77]
    v_pk_add_f32 v[74:75], v[74:75], v[78:79]
    v_pk_add_f32 v[64:65], v[64:65], v[72:73]
    v_pk_add_f32 v[66:67], v[66:67], v[74:75]
    s_waitcnt lgkmcnt(2)
    v_pk_add_f32 v[80:81], v[80:81], v[84:85]
    v_pk_add_f32 v[82:83], v[82:83], v[86:87]
    v_pk_add_f32 v[64:65], v[64:65], v[80:81]
    v_pk_add_f32 v[66:67], v[66:67], v[82:83]
    s_waitcnt lgkmcnt(0)
    v_pk_add_f32 v[88:89], v[88:89], v[92:93]
    v_pk_add_f32 v[90:91], v[90:91], v[94:95]
    v_pk_add_f32 v[64:65], v[64:65], v[88:89]
    v_pk_add_f32 v[66:67], v[66:67], v[90:91]
    v_cvt_pk_bf16_f32 v64, v64, v65
    v_cvt_pk_bf16_f32 v65, v66, v67
    buffer_store_dwordx2 v[64:65], v50, s[4:7], s70 offen sc1
HMDONE:
    v_mov_b32 v45, v59
    s_branch HM2
NOHM:
    s_waitcnt vmcnt(4)
    ds_write_b128 v60, v[192:195] offset:0
    ds_write_b128 v60, v[196:199] offset:1024
    ds_write_b128 v59, v[200:203] offset:0
    ds_write_b128 v59, v[204:207] offset:1024
    s_waitcnt vmcnt(0) lgkmcnt(0)
    s_barrier
HM2:
    v_lshrrev_b32 v47, 2, v2
    v_and_b32 v48, 1, v3
    v_lshl_or_b32 v48, v48, 2, v47
    v_lshlrev_b32 v48, 1, v48
    v_bfe_u32 v49, v2, 1, 1
    s_lshl_b32 s67, s3, 1
    v_or_b32 v49, s67, v49
    v_xor_b32 v48, v48, v49
    v_lshlrev_b32 v48, 4, v48
    v_and_b32 v49, 1, v2
    v_lshl_or_b32 v48, v49, 3, v48
    v_lshl_add_u32 v49, v3, 3, v47
    v_lshl_or_b32 v46, v49, 8, v48
    v_add_u32 v46, 32768, v46
    ds_read_b64_tr_b16 v[96:97], v46 offset:0
    ds_read_b64_tr_b16 v[98:99], v46 offset:1024
    ds_read_b64_tr_b16 v[100:101], v46 offset:8192
    ds_read_b64_tr_b16 v[102:103], v46 offset:9216
    ds_read_b64_tr_b16 v[104:105], v46 offset:16384
    ds_read_b64_tr_b16 v[106:107], v46 offset:17408
    ds_read_b64_tr_b16 v[108:109], v46 offset:24576
    ds_read_b64_tr_b16 v[110:111], v46 offset:25600
    v_mov_b32 v58, v45
    v_lshrrev_b32 v47, 2, v2
    v_and_b32 v48, 2, v47
    v_and_b32 v49, 1, v3
    v_lshl_or_b32 v48, v49, 2, v48
    v_bfe_u32 v49, v2, 1, 1
    v_or_b32 v48, v48, v49
    v_lshlrev_b32 v48, 4, v48
    v_and_b32 v49, 1, v2
    v_lshl_or_b32 v48, v49, 3, v48
    v_lshl_add_u32 v50, v3, 3, v47
    v_lshl_or_b32 v44, v50, 7, v48
    v_add_u32 v44, s73, v44
    v_xor_b32 v45, 32, v44
    v_xor_b32 v46, 64, v44
    v_xor_b32 v47, 96, v44
    ds_read_b64_tr_b16 v[64:65], v44 offset:0
    ds_read_b64_tr_b16 v[66:67], v44 offset:512
    ds_read_b64_tr_b16 v[68:69], v45 offset:0
    ds_read_b64_tr_b16 v[70:71], v45 offset:512
    ds_read_b64_tr_b16 v[72:73], v46 offset:0
    ds_read_b64_tr_b16 v[74:75], v46 offset:512
    ds_read_b64_tr_b16 v[76:77], v47 offset:0
    ds_read_b64_tr_b16 v[78:79], v47 offset:512
    v_lshrrev_b32 v48, 3, v2
    v_lshlrev_b32 v49, 13, v48
    v_lshl_or_b32 v49, v3, 7, v49
    v_lshlrev_b32 v60, 10, v48
    v_lshl_or_b32 v60, v3, 3, v60
    v_lshrrev_b32 v48, 1, v3
    v_lshlrev_b32 v48, 3, v48
    v_or_b32 v51, s3, v48
    v_xor_b32 v50, v48, v2
    v_xor_b32 v50, s79, v50
    v_lshlrev_b32 v50, 4, v50
    v_lshl_or_b32 v50, v51, 8, v50
    v_xor_b32 v51, v2, v3
    v_and_b32 v51, 1, v51
    v_lshl_or_b32 v50, v51, 3, v50
    v_lshlrev_b32 v59, 3, v2
    s_lshl_b32 s70, s3, 3
    v_add_u32 v51, s70, v59
    v_cmp_gt_u32 vcc, 8, v2
    s_nop 1
    v_cndmask_b32 v224, 0, v32, vcc
    v_xor_b32 v228, v224, v32
    v_cndmask_b32 v225, 0, v33, vcc
    v_xor_b32 v229, v225, v33
    v_cndmask_b32 v226, 0, v34, vcc
    v_xor_b32 v230, v226, v34
    v_cndmask_b32 v227, 0, v35, vcc
    v_xor_b32 v231, v227, v35
    s_add_u32 s68, s78, 65536
    s_add_u32 s69, s78, 1048576
    s_add_u32 s70, s78, 1114112
MLL:
    buffer_load_dwordx2 v[44:45], v49, s[4:7], s72 offen offset:0 sc1
    buffer_load_dwordx2 v[46:47], v49, s[4:7], s72 offen offset:512 sc1
MLW:
    s_waitcnt vmcnt(0)
    v_max_u32 v82, v45, v47
    v_cmp_eq_u32 vcc, -1, v82
    s_nop 0
    s_cbranch_vccz MLOK
    s_mov_b32 exec_lo, 0x0
    s_mov_b32 exec_hi, 0x80000000
MLG:
    v_cmp_eq_u32 vcc, -1, v47
    s_nop 0
    s_cbranch_vccz MLR
    buffer_load_dwordx2 v[46:47], v49, s[4:7], s72 offen offset:512 sc1
    s_add_u32 s71, s71, 1
    s_cmp_lt_u32 s71, 65536
    s_waitcnt vmcnt(0)
    s_cbranch_scc1 MLG
MLR:
    s_mov_b64 exec, -1
    v_cmp_eq_u32 vcc, -1, v45
    s_mov_b64 exec, vcc
    buffer_load_dwordx2 v[44:45], v49, s[4:7], s72 offen offset:0 sc1
    s_mov_b64 exec, -1
    v_cmp_eq_u32 vcc, -1, v47
    s_mov_b64 exec, vcc
    buffer_load_dwordx2 v[46:47], v49, s[4:7], s72 offen offset:512 sc1
    s_mov_b64 exec, -1
    s_waitcnt vmcnt(0)
    s_add_u32 s71, s71, 1
    s_cmp_lt_u32 s71, 65536
    s_cbranch_scc1 MLW
MLOK:
    buffer_load_dwordx4 v[128:131], v58, s[4:7], s78 offen sc1
    buffer_load_dwordx4 v[132:135], v58, s[4:7], s68 offen sc1
    buffer_load_dwordx4 v[136:139], v58, s[4:7], s69 offen sc1
    buffer_load_dwordx4 v[140:143], v58, s[4:7], s70 offen sc1
    v_max_f32 v52, v44, v46
    v_mov_b32 v53, v52
    s_nop 1
    v_permlane32_swap_b32 v52, v53
    v_max_f32 v52, v52, v53
    v_mov_b32 v53, v52
    s_nop 1
    v_permlane16_swap_b32 v52, v53
    v_max_f32 v52, v52, v53
    v_sub_f32 v80, v44, v52
    v_sub_f32 v81, v46, v52
    v_exp_f32 v80, v80
    v_exp_f32 v81, v81
    v_cvt_pk_bf16_f32 v80, v80, v80
    v_cvt_pk_bf16_f32 v81, v81, v81
    v_and_b32 v144, v80, v224
    v_and_b32 v145, v80, v225
    v_and_b32 v146, v80, v226
    v_and_b32 v147, v80, v227
    v_and_b32 v148, v81, v224
    v_and_b32 v149, v81, v225
    v_and_b32 v150, v81, v226
    v_and_b32 v151, v81, v227
    v_and_b32 v152, v80, v228
    v_and_b32 v153, v80, v229
    v_and_b32 v154, v80, v230
    v_and_b32 v155, v80, v231
    v_and_b32 v156, v81, v228
    v_and_b32 v157, v81, v229
    v_and_b32 v158, v81, v230
    v_and_b32 v159, v81, v231
    v_and_b32 v80, 0xffff0000, v80
    v_and_b32 v81, 0xffff0000, v81
    v_mul_f32 v53, v80, v45
    v_fmac_f32 v53, v81, v47
    v_mov_b32 v82, v53
    s_nop 1
    v_permlane32_swap_b32 v53, v82
    v_add_f32 v53, v53, v82
    v_mov_b32 v82, v53
    s_nop 1
    v_permlane16_swap_b32 v53, v82
    v_add_f32 v53, v53, v82
    s_mov_b64 exec, 0x0101
    ds_write_b64 v51, v[52:53] offset:20992
    s_mov_b64 exec, -1
    s_lshl_b32 s67, s76, 3
    s_add_u32 s67, s67, s77
    s_lshl_b32 s67, s67, 3
    s_add_u32 s67, s67, s3
    s_lshl_b32 s67, s67, 5
    s_add_u32 s67, s67, 131072
    s_branch H4W
H4L:
    buffer_load_dwordx4 v[128:131], v58, s[4:7], s78 offen sc1
    buffer_load_dwordx4 v[132:135], v58, s[4:7], s68 offen sc1
    buffer_load_dwordx4 v[136:139], v58, s[4:7], s69 offen sc1
    buffer_load_dwordx4 v[140:143], v58, s[4:7], s70 offen sc1
H4W:
    s_waitcnt vmcnt(3)
    v_mfma_f32_16x16x32_bf16 v[208:211], v[144:147], v[128:131], 0
    s_waitcnt vmcnt(2)
    v_mfma_f32_16x16x32_bf16 v[208:211], v[148:151], v[132:135], v[208:211]
    s_waitcnt vmcnt(1)
    v_mfma_f32_16x16x32_bf16 v[208:211], v[152:155], v[136:139], v[208:211]
    s_waitcnt vmcnt(0)
    v_mfma_f32_16x16x32_bf16 v[208:211], v[156:159], v[140:143], v[208:211]
    v_max3_u32 v82, v131, v135, v139
    v_max_u32 v82, v82, v143
    v_cmp_eq_u32 vcc, -1, v82
    s_nop 0
    s_cbranch_vccz H4OK
    s_add_u32 s71, s71, 1
    s_cmp_lt_u32 s71, 65536
    s_cbranch_scc1 H4L
H4OK:
    s_nop 2
    v_cvt_pk_bf16_f32 v208, v208, v209
    v_cvt_pk_bf16_f32 v209, v210, v211
    ds_write_b64 v50, v[208:209] offset:16384
    s_waitcnt lgkmcnt(0)
    s_barrier
    ds_read_b64 v[52:53], v59 offset:20992
    ds_read_b128 v[80:83], v4 offset:16384
    ds_read_b128 v[84:87], v5 offset:16384
    ds_read_b128 v[88:91], v6 offset:16384
    ds_read_b128 v[92:95], v7 offset:16384
    s_waitcnt lgkmcnt(4)
    v_max_f32_dpp v44, v52, v52 quad_perm:[1,0,3,2] row_mask:0xf bank_mask:0xf
    s_waitcnt lgkmcnt(3)
    v_mfma_f32_16x16x32_bf16 v[212:215], v[96:99], v[80:83], 0
    v_max_f32_dpp v44, v44, v44 quad_perm:[2,3,0,1] row_mask:0xf bank_mask:0xf
    s_waitcnt lgkmcnt(2)
    v_mfma_f32_16x16x32_bf16 v[212:215], v[100:103], v[84:87], v[212:215]
    v_max_f32_dpp v44, v44, v44 row_half_mirror row_mask:0xf bank_mask:0xf
    s_waitcnt lgkmcnt(1)
    v_mfma_f32_16x16x32_bf16 v[212:215], v[104:107], v[88:91], v[212:215]
    v_sub_f32 v44, v52, v44
    v_exp_f32 v44, v44
    s_waitcnt lgkmcnt(0)
    v_mfma_f32_16x16x32_bf16 v[212:215], v[108:111], v[92:95], v[212:215]
    v_mul_f32 v53, v53, v44
    s_nop 1
    v_add_f32_dpp v53, v53, v53 quad_perm:[1,0,3,2] row_mask:0xf bank_mask:0xf
    s_nop 1
    v_add_f32_dpp v53, v53, v53 quad_perm:[2,3,0,1] row_mask:0xf bank_mask:0xf
    s_nop 1
    v_add_f32_dpp v53, v53, v53 row_half_mirror row_mask:0xf bank_mask:0xf
    v_rcp_f32 v53, v53
    v_mul_f32 v212, v212, v44
    v_mul_f32 v213, v213, v44
    v_mul_f32 v214, v214, v44
    v_mul_f32 v215, v215, v44
    v_add_f32_dpp v212, v212, v212 quad_perm:[1,0,3,2] row_mask:0xf bank_mask:0xf
    v_add_f32_dpp v213, v213, v213 quad_perm:[1,0,3,2] row_mask:0xf bank_mask:0xf
    v_add_f32_dpp v214, v214, v214 quad_perm:[1,0,3,2] row_mask:0xf bank_mask:0xf
    v_add_f32_dpp v215, v215, v215 quad_perm:[1,0,3,2] row_mask:0xf bank_mask:0xf
    v_add_f32_dpp v212, v212, v212 quad_perm:[2,3,0,1] row_mask:0xf bank_mask:0xf
    v_add_f32_dpp v213, v213, v213 quad_perm:[2,3,0,1] row_mask:0xf bank_mask:0xf
    v_add_f32_dpp v214, v214, v214 quad_perm:[2,3,0,1] row_mask:0xf bank_mask:0xf
    v_add_f32_dpp v215, v215, v215 quad_perm:[2,3,0,1] row_mask:0xf bank_mask:0xf
    v_add_f32_dpp v212, v212, v212 row_half_mirror row_mask:0xf bank_mask:0xf
    v_add_f32_dpp v213, v213, v213 row_half_mirror row_mask:0xf bank_mask:0xf
    v_add_f32_dpp v214, v214, v214 row_half_mirror row_mask:0xf bank_mask:0xf
    v_add_f32_dpp v215, v215, v215 row_half_mirror row_mask:0xf bank_mask:0xf
    v_mul_f32 v212, v212, v53
    v_mul_f32 v213, v213, v53
    v_mul_f32 v214, v214, v53
    v_mul_f32 v215, v215, v53
    v_cvt_pk_bf16_f32 v212, v212, v213
    v_cvt_pk_bf16_f32 v213, v214, v215
    s_mov_b32 exec_lo, 0x01010101
    s_mov_b32 exec_hi, 0x01010101
    ds_write_b64 v252, v[212:213] offset:20480
    s_mov_b64 exec, -1
    v_lshlrev_b32 v254, 10, v3
    v_lshl_or_b32 v254, v2, 4, v254
    s_cmp_lg_u32 s3, 0
    s_waitcnt lgkmcnt(0)
    s_barrier
    s_cbranch_scc1 P4_E
    s_mov_b32 exec_hi, 0
    ds_read_b128 v[212:215], v253 offset:20480
    s_waitcnt lgkmcnt(0)
    buffer_store_dwordx4 v[212:215], v254, s[4:7], s67 offen sc1
P4_E:
    s_mov_b64 exec, -1
    v_and_b32 v48, 7, v2
    v_lshlrev_b32 v48, 8, v48
    v_lshl_or_b32 v48, v3, 4, v48
    s_lshl_b32 s68, s64, 1
    s_lshr_b32 s67, s66, 3
    s_add_u32 s68, s68, s67
    s_lshl_b32 s67, s68, 1
    s_lshr_b32 s69, s3, 2
    s_add_u32 s67, s67, s69
    s_lshl_b32 s67, s67, 11
    s_and_b32 s69, s3, 3
    s_lshl_b32 s69, s69, 6
    s_add_u32 s67, s67, s69
    s_add_u32 s67, s67, 131072
    s_lshl_b32 s68, s68, 10
    s_and_b32 s69, s66, 7
    s_lshl_b32 s69, s69, 7
    s_add_u32 s68, s68, s69
    s_add_u32 s68, s68, 196608
    s_lshl_b32 s69, s3, 9
    v_lshlrev_b32 v49, 2, v2
    v_lshl_or_b32 v49, v3, 8, v49
    v_add_u32 v49, s69, v49
    v_lshlrev_b32 v50, 4, v1
    v_lshlrev_b32 v51, 3, v2
    v_lshl_or_b32 v51, v3, 14, v51
    s_waitcnt lgkmcnt(0)
S8L:
    buffer_load_dwordx4 v[36:39], v48, s[4:7], s67 offen sc1
S8W:
    s_waitcnt vmcnt(0)
    v_mfma_f32_16x16x32_bf16 v[208:211], v[36:39], v[64:67], 0
    v_mfma_f32_16x16x32_bf16 v[212:215], v[36:39], v[68:71], 0
    v_mfma_f32_16x16x32_bf16 v[216:219], v[36:39], v[72:75], 0
    v_mfma_f32_16x16x32_bf16 v[220:223], v[36:39], v[76:79], 0
    v_cmp_eq_u32 vcc, -1, v39
    s_nop 0
    s_cbranch_vccz S8OK
    s_add_u32 s71, s71, 1
    s_cmp_lt_u32 s71, 65536
    s_cbranch_scc1 S8L
S8OK:
    s_nop 1
    v_pk_add_f32 v[208:209], v[208:209], v[210:211]
    v_pk_add_f32 v[212:213], v[212:213], v[214:215]
    v_pk_add_f32 v[216:217], v[216:217], v[218:219]
    v_pk_add_f32 v[220:221], v[220:221], v[222:223]
    v_add_f32 v208, v208, v209
    v_add_f32 v212, v212, v213
    v_add_f32 v216, v216, v217
    v_add_f32 v220, v220, v221
    s_mov_b32 exec_hi, 0
    ds_write2_b32 v49, v208, v212 offset0:0 offset1:16
    ds_write2_b32 v49, v216, v220 offset0:32 offset1:48
    s_waitcnt lgkmcnt(0)
    s_barrier
    s_cmp_lg_u32 s3, 0
    s_cbranch_scc1 FIN
    ds_read_b128 v[64:67], v50 offset:0
    ds_read_b128 v[68:71], v50 offset:512
    ds_read_b128 v[72:75], v50 offset:1024
    ds_read_b128 v[76:79], v50 offset:1536
    ds_read_b128 v[80:83], v50 offset:2048
    ds_read_b128 v[84:87], v50 offset:2560
    ds_read_b128 v[88:91], v50 offset:3072
    ds_read_b128 v[92:95], v50 offset:3584
    s_waitcnt lgkmcnt(6)
    v_pk_add_f32 v[64:65], v[64:65], v[68:69]
    v_pk_add_f32 v[66:67], v[66:67], v[70:71]
    s_waitcnt lgkmcnt(4)
    v_pk_add_f32 v[72:73], v[72:73], v[76:77]
    v_pk_add_f32 v[74:75], v[74:75], v[78:79]
    v_pk_add_f32 v[64:65], v[64:65], v[72:73]
    v_pk_add_f32 v[66:67], v[66:67], v[74:75]
    s_waitcnt lgkmcnt(2)
    v_pk_add_f32 v[80:81], v[80:81], v[84:85]
    v_pk_add_f32 v[82:83], v[82:83], v[86:87]
    v_pk_add_f32 v[64:65], v[64:65], v[80:81]
    v_pk_add_f32 v[66:67], v[66:67], v[82:83]
    s_waitcnt lgkmcnt(0)
    v_pk_add_f32 v[88:89], v[88:89], v[92:93]
    v_pk_add_f32 v[90:91], v[90:91], v[94:95]
    v_pk_add_f32 v[64:65], v[64:65], v[88:89]
    v_pk_add_f32 v[66:67], v[66:67], v[90:91]
    v_cvt_pk_bf16_f32 v64, v64, v65
    v_cvt_pk_bf16_f32 v65, v66, v67
    buffer_store_dwordx2 v[64:65], v51, s[4:7], s68 offen sc1
FIN:
    s_waitcnt vmcnt(0)
END:
    s_endpgm
.section .rodata,"a"
.p2align 6
.amdhsa_kernel adaLN_cond__compressed_kv_cla__mixer_channel_mlp__decode_kernel
  .amdhsa_next_free_vgpr 256
  .amdhsa_next_free_sgpr 102
  .amdhsa_accum_offset 256
  .amdhsa_group_segment_fixed_size 0
  .amdhsa_kernarg_size 128
  .amdhsa_user_sgpr_count 2
  .amdhsa_user_sgpr_kernarg_segment_ptr 1
  .amdhsa_system_sgpr_workgroup_id_x 1
.end_amdhsa_kernel
```
